```python
import torch

def _softmax(x, axis=-1):
    return torch.softmax(x, dim=axis)
def _gelu(x):
    return torch.nn.functional.gelu(x, approximate="tanh")
def _silu(x):
    return torch.nn.functional.silu(x)
def _sigmoid(x):
    return torch.sigmoid(x)
def _layernorm(x, axis=-1, eps=1e-5):
    m = x.mean(dim=axis, keepdim=True)
    v = x.var(dim=axis, keepdim=True, unbiased=False)
    return (x - m) / torch.sqrt(v + eps)
def _scatter_add(tgt, idx, src, axis=0):
    return tgt.clone().index_add_(axis, idx, src)
def _segment_sum(src, seg, n):
    out = torch.zeros((n,) + src.shape[1:], dtype=src.dtype)
    return out.index_add_(0, seg, src)
def _pad(x, pw):
    flat = tuple(v for pair in reversed(pw) for v in pair)
    return torch.nn.functional.pad(x, flat)

kernel_name = 'standalone__mha_block_cached__near_ridge'

def setup_inputs():

    _w = (lambda a: (lambda t: t.to(torch.bfloat16) if t.is_floating_point() else t)(torch.as_tensor(a)))
    B, Sq, D = 32, 32, 448
    H, Sk, Dh = 16, 32, 256
    return {
        "x": _w((lambda *s: torch.randn(*s, dtype=torch.bfloat16) * 0.8)(B, Sq, D)),
        "k_cache": _w((lambda *s: torch.randn(*s, dtype=torch.bfloat16) * 0.8)(B, H, Sk, Dh)),
        "v_cache": _w((lambda *s: torch.randn(*s, dtype=torch.bfloat16) * 0.05)(B, H, Sk, Dh)),
        "wq": _w((lambda *s: torch.randn(*s, dtype=torch.bfloat16) * 0.8)(D, H * Dh) * (D ** -0.5)),
        "wo": _w((lambda *s: torch.randn(*s, dtype=torch.bfloat16) * 0.05)(H * Dh, D) * ((H * Dh) ** -0.5)),
    }

def reference(x, k_cache, v_cache, wq, wo):
    B, Sq, D = x.shape
    H, Dh = 16, 256
    q = (lambda x, *d: x.permute(*d))((x @ wq).reshape(B, Sq, H, Dh), 0, 2, 1, 3)
    scores = torch.einsum("bhqd,bhkd->bhqk", q, k_cache) * (Dh ** -0.5)
    p = _softmax(scores, axis=-1)
    o = torch.einsum("bhqk,bhkd->bhqd", p, v_cache)
    return (lambda x, *d: x.permute(*d))(o, 0, 2, 1, 3).reshape(B, Sq, H * Dh) @ wo
```

```asm
; @launch grid=(256,1,1) block=(512,1,1) lds=155648
.amdgcn_target "amdgcn-amd-amdhsa--gfx950"
.text
.p2align 12
.globl standalone__mha_block_cached__near_ridge_kernel
.p2align 8
.type standalone__mha_block_cached__near_ridge_kernel,@function
standalone__mha_block_cached__near_ridge_kernel:
    s_cmp_ge_u32 s2, 256
    s_cbranch_scc1 L_end
    s_load_dwordx2 s[20:21], s[0:1], 0
    s_load_dwordx2 s[32:33], s[0:1], 24
    v_lshrrev_b32 v1, 6, v0
    v_and_b32 v0, 63, v0
    v_readfirstlane_b32 s48, v1
    s_load_dwordx2 s[40:41], s[0:1], 56
    s_cmp_lt_u32 s48, 4
    s_cbranch_scc1 L_compute
    s_setprio 3
    s_and_b32 s49, s48, 3
    s_lshr_b32 s52, s2, 4
    s_bfe_u32 s51, s2, 0x10003
    s_mul_i32 s55, s52, 7
    s_mul_i32 s54, s51, 3
    s_lshr_b32 s57, s55, 4
    s_bfe_u32 s56, s55, 0x10003
    s_add_u32 s57, s57, s54
    v_lshrrev_b32 v2, 3, v0
    v_lshrrev_b32 v1, 4, v0
    v_xor_b32 v3, v0, v1
    v_and_b32 v3, 7, v3
    s_cmp_ge_u32 s57, 7
    v_lshlrev_b32 v3, 4, v3
    s_cselect_b32 s54, 7, 0
    s_sub_u32 s60, s57, s54
    s_mov_b32 s10, 896
    s_lshl_b32 s7, s52, 2
    v_mad_u32_u24 v4, v2, s10, v3
    s_add_u32 s11, s7, s49
    s_mul_i32 s11, s11, 14336
    s_lshl_b32 s67, s60, 7
    v_xor_b32 v5, 64, v4
    s_add_u32 s67, s67, s11
    s_lshl_b32 s5, s49, 11
    s_add_u32 m0, s5, 98304
    s_mov_b32 s22, 917504
    s_mov_b32 s23, 0x00020000
    s_waitcnt lgkmcnt(0)
    buffer_load_dwordx4 v4, s[20:23], s67 offen lds
    v_add_u32 v7, 18432, v5
    v_add_u32 v5, 6144, v5
    v_lshlrev_b32 v24, 1, v0
    v_and_b32 v24, 32, v24
    v_and_b32 v1, 7, v0
    v_lshlrev_b32 v1, 4, v1
    buffer_load_dwordx4 v5, s[20:23], s67 offen offset:1024 lds
    v_xor_b32 v24, v24, v1
    v_lshl_add_u32 v8, v2, 13, v24
    s_and_b32 s53, s2, 7
    s_lshl_b32 s53, s53, 1
    s_add_u32 s53, s53, s51
    s_lshl_b32 s58, s53, 2
    s_add_u32 s58, s58, s49
    s_lshl_b32 s58, s58, 7
    s_lshl_b32 s54, s56, 18
    s_xor_b32 s59, s54, 262144
    s_add_u32 s59, s59, s58
    s_add_u32 s58, s58, s54
    s_lshl_b32 s12, s60, 19
    s_add_u32 s12, s12, s58
    s_mul_i32 s4, s49, 24576
    s_mov_b32 m0, s4
    s_mov_b32 s34, 3670016
    s_mov_b32 s35, 0x00020000
    buffer_load_dwordx4 v8, s[32:35], s12 offen lds
    v_xor_b32 v9, 64, v8
    v_add_u32 v10, 129024, v8
    v_add_u32 v11, 193536, v9
    v_add_u32 v9, 64512, v9
    s_load_dwordx2 s[24:25], s[0:1], 8
    s_load_dwordx2 s[28:29], s[0:1], 16
    s_load_dwordx2 s[36:37], s[0:1], 32
    v_add_u32 v6, 12288, v4
    s_lshr_b32 s8, s49, 1
    s_and_b32 s9, s49, 1
    s_lshl_b32 s7, s52, 1
    s_add_u32 s7, s7, s9
    buffer_load_dwordx4 v9, s[32:35], s12 offen offset:1024 lds
    s_mul_i32 s11, s7, 28672
    s_lshl_b32 s5, s49, 12
    s_add_u32 s5, s5, 106496
    s_add_u32 s61, s60, 1
    s_cmp_ge_u32 s61, 7
    s_cselect_b32 s54, 7, 0
    s_sub_u32 s61, s61, s54
    s_add_u32 s62, s60, 2
    buffer_load_dwordx4 v10, s[32:35], s12 offen offset:2048 lds
    s_cmp_ge_u32 s62, 7
    s_cselect_b32 s54, 7, 0
    s_sub_u32 s62, s62, s54
    s_add_u32 s63, s60, 3
    s_cmp_ge_u32 s63, 7
    s_cselect_b32 s54, 7, 0
    s_sub_u32 s63, s63, s54
    s_add_u32 s64, s60, 4
    buffer_load_dwordx4 v11, s[32:35], s12 offen offset:3072 lds
    s_cmp_ge_u32 s64, 7
    s_cselect_b32 s54, 7, 0
    s_sub_u32 s64, s64, s54
    s_add_u32 s65, s60, 5
    s_cmp_ge_u32 s65, 7
    s_cselect_b32 s54, 7, 0
    s_sub_u32 s65, s65, s54
    s_add_u32 s66, s60, 6
    s_cmp_ge_u32 s66, 7
    s_cselect_b32 s54, 7, 0
    s_sub_u32 s66, s66, s54
    s_cmp_eq_u32 s8, 0
    s_cselect_b32 s68, s61, s62
    s_lshl_b32 s68, s68, 7
    s_add_u32 s68, s68, s11
    s_cmp_eq_u32 s8, 0
    s_cselect_b32 s69, s63, s64
    s_lshl_b32 s69, s69, 7
    s_add_u32 s69, s69, s11
    s_cmp_eq_u32 s8, 0
    s_cselect_b32 s47, s65, s66
    s_lshl_b32 s47, s47, 7
    s_add_u32 s47, s47, s11
    s_lshl_b32 s60, s60, 19
    s_lshl_b32 s61, s61, 19
    s_lshl_b32 s62, s62, 19
    s_lshl_b32 s63, s63, 19
    s_lshl_b32 s64, s64, 19
    s_lshl_b32 s65, s65, 19
    s_lshl_b32 s66, s66, 19
    s_add_u32 m0, s4, 4096
    s_add_u32 s57, s60, s59
    buffer_load_dwordx4 v8, s[32:35], s57 offen lds
    buffer_load_dwordx4 v9, s[32:35], s57 offen offset:1024 lds
    buffer_load_dwordx4 v10, s[32:35], s57 offen offset:2048 lds
    buffer_load_dwordx4 v11, s[32:35], s57 offen offset:3072 lds
    s_add_u32 m0, s5, 0
    s_nop 0
    buffer_load_dwordx4 v4, s[20:23], s68 offen lds
    buffer_load_dwordx4 v5, s[20:23], s68 offen offset:1024 lds
    buffer_load_dwordx4 v6, s[20:23], s68 offen offset:2048 lds
    buffer_load_dwordx4 v7, s[20:23], s68 offen offset:3072 lds
    v_lshl_add_u32 v12, v2, 9, v3
    v_xor_b32 v13, 64, v12
    v_add_u32 v14, 6144, v12
    v_add_u32 v15, 9216, v13
    v_add_u32 v13, 3072, v13
    v_mad_u32_u24 v16, v2, s10, v24
    v_xor_b32 v17, 64, v16
    v_add_u32 v18, 12288, v16
    v_add_u32 v19, 18432, v17
    v_add_u32 v17, 6144, v17
    v_and_b32 v1, 4, v2
    v_add_u32 v1, v1, v2
    v_lshl_add_u32 v28, v1, 9, v3
    v_xor_b32 v29, 64, v28
    v_add_u32 v30, 6144, v28
    v_add_u32 v31, 7168, v29
    v_add_u32 v29, 1024, v29
    v_lshlrev_b32 v20, 4, v0
    s_lshl_b32 s44, s7, 4
    s_add_u32 s44, s44, s53
    s_lshl_b32 s44, s44, 6
    s_add_u32 s44, s44, s8
    s_lshl_b32 s44, s44, 8
    s_and_b32 s50, s2, 7
    s_lshr_b32 s55, s2, 3
    s_mul_i32 s99, s55, 37
    s_lshr_b32 s99, s99, 8
    s_mul_i32 s98, s99, 7
    s_sub_u32 s98, s55, s98
    s_cmp_ge_u32 s55, 28
    s_cselect_b32 s99, s98, s99
    s_cselect_b32 s98, 7, s98
    s_and_b32 s100, s50, 4
    s_add_u32 s100, s100, s99
    s_add_u32 s101, s50, s98
    s_add_u32 s101, s101, 1
    s_and_b32 s101, s101, 3
    s_lshr_b32 s3, s98, 2
    s_lshl_b32 s3, s3, 1
    s_add_u32 s3, s3, s99
    s_and_b32 s3, s3, 3
    s_and_b32 s55, s50, 3
    s_lshl_b32 s55, s55, 2
    s_add_u32 s55, s55, s49
    s_mul_i32 s46, s55, 229376
    s_min_u32 s54, s98, 6
    s_lshl_b32 s54, s54, 7
    s_add_u32 s46, s46, s54
    s_lshl_b32 s45, s100, 6
    s_add_u32 s45, s45, s55
    s_lshl_b32 s6, s45, 11
    s_add_u32 s6, s6, 1048576
    s_lshl_b32 s45, s45, 14
    s_mov_b32 s26, 8388608
    s_mov_b32 s27, 0x00020000
    s_mov_b32 s30, 8388608
    s_mov_b32 s31, 0x00020000
    s_mov_b32 s38, 3670016
    s_mov_b32 s39, 0x00020000
    s_mov_b32 s42, 7602176
    s_mov_b32 s43, 0x00020000
    s_waitcnt lgkmcnt(0)
    s_setprio 0
    s_bitcmp1_b32 s2, 3
    s_cbranch_scc1 L_loader1
L_loader0:
    s_add_u32 m0, s4, 8192
    s_add_u32 s57, s44, 0
    s_waitcnt vmcnt(12)
    s_barrier
    buffer_load_dwordx4 v12, s[24:27], s57 offen lds
    buffer_load_dwordx4 v13, s[24:27], s57 offen offset:1024 lds
    buffer_load_dwordx4 v14, s[24:27], s57 offen offset:2048 lds
    buffer_load_dwordx4 v15, s[24:27], s57 offen offset:3072 lds
    s_add_u32 m0, s4, 12288
    s_add_u32 s57, s44, 128
    s_waitcnt vmcnt(12)
    s_barrier
    buffer_load_dwordx4 v12, s[24:27], s57 offen lds
    buffer_load_dwordx4 v13, s[24:27], s57 offen offset:1024 lds
    buffer_load_dwordx4 v14, s[24:27], s57 offen offset:2048 lds
    buffer_load_dwordx4 v15, s[24:27], s57 offen offset:3072 lds
    s_add_u32 m0, s4, 16384
    s_add_u32 s57, s61, s58
    s_waitcnt vmcnt(12)
    s_barrier
    buffer_load_dwordx4 v8, s[32:35], s57 offen lds
    buffer_load_dwordx4 v9, s[32:35], s57 offen offset:1024 lds
    buffer_load_dwordx4 v10, s[32:35], s57 offen offset:2048 lds
    buffer_load_dwordx4 v11, s[32:35], s57 offen offset:3072 lds
    s_add_u32 m0, s4, 20480
    s_add_u32 s57, s61, s59
    s_waitcnt vmcnt(12)
    s_barrier
    buffer_load_dwordx4 v8, s[32:35], s57 offen lds
    buffer_load_dwordx4 v9, s[32:35], s57 offen offset:1024 lds
    buffer_load_dwordx4 v10, s[32:35], s57 offen offset:2048 lds
    buffer_load_dwordx4 v11, s[32:35], s57 offen offset:3072 lds
    s_add_u32 m0, s4, 0
    s_add_u32 s57, s62, s58
    s_waitcnt vmcnt(12)
    s_barrier
    buffer_load_dwordx4 v8, s[32:35], s57 offen lds
    buffer_load_dwordx4 v9, s[32:35], s57 offen offset:1024 lds
    buffer_load_dwordx4 v10, s[32:35], s57 offen offset:2048 lds
    buffer_load_dwordx4 v11, s[32:35], s57 offen offset:3072 lds
    s_add_u32 m0, s4, 4096
    s_add_u32 s57, s62, s59
    s_waitcnt vmcnt(12)
    s_barrier
    buffer_load_dwordx4 v8, s[32:35], s57 offen lds
    buffer_load_dwordx4 v9, s[32:35], s57 offen offset:1024 lds
    buffer_load_dwordx4 v10, s[32:35], s57 offen offset:2048 lds
    buffer_load_dwordx4 v11, s[32:35], s57 offen offset:3072 lds
    s_add_u32 m0, s5, 16384
    s_nop 0
    s_waitcnt vmcnt(12)
    s_barrier
    buffer_load_dwordx4 v4, s[20:23], s69 offen lds
    buffer_load_dwordx4 v5, s[20:23], s69 offen offset:1024 lds
    buffer_load_dwordx4 v6, s[20:23], s69 offen offset:2048 lds
    buffer_load_dwordx4 v7, s[20:23], s69 offen offset:3072 lds
    s_add_u32 m0, s4, 8192
    s_add_u32 s57, s63, s58
    s_waitcnt vmcnt(12)
L_ljoin:
    s_barrier
    buffer_load_dwordx4 v8, s[32:35], s57 offen lds
    buffer_load_dwordx4 v9, s[32:35], s57 offen offset:1024 lds
    buffer_load_dwordx4 v10, s[32:35], s57 offen offset:2048 lds
    buffer_load_dwordx4 v11, s[32:35], s57 offen offset:3072 lds
    s_add_u32 m0, s4, 12288
    s_add_u32 s57, s63, s59
    s_waitcnt vmcnt(12)
    s_barrier
    buffer_load_dwordx4 v8, s[32:35], s57 offen lds
    buffer_load_dwordx4 v9, s[32:35], s57 offen offset:1024 lds
    buffer_load_dwordx4 v10, s[32:35], s57 offen offset:2048 lds
    buffer_load_dwordx4 v11, s[32:35], s57 offen offset:3072 lds
    s_add_u32 m0, s4, 16384
    s_add_u32 s57, s64, s58
    s_waitcnt vmcnt(12)
    s_barrier
    buffer_load_dwordx4 v8, s[32:35], s57 offen lds
    buffer_load_dwordx4 v9, s[32:35], s57 offen offset:1024 lds
    buffer_load_dwordx4 v10, s[32:35], s57 offen offset:2048 lds
    buffer_load_dwordx4 v11, s[32:35], s57 offen offset:3072 lds
    s_add_u32 m0, s5, 32768
    s_nop 0
    s_waitcnt vmcnt(12)
    s_barrier
    buffer_load_dwordx4 v4, s[20:23], s47 offen lds
    buffer_load_dwordx4 v5, s[20:23], s47 offen offset:1024 lds
    buffer_load_dwordx4 v6, s[20:23], s47 offen offset:2048 lds
    buffer_load_dwordx4 v7, s[20:23], s47 offen offset:3072 lds
    s_add_u32 m0, s4, 20480
    s_add_u32 s57, s64, s59
    s_waitcnt vmcnt(12)
    s_barrier
    buffer_load_dwordx4 v8, s[32:35], s57 offen lds
    buffer_load_dwordx4 v9, s[32:35], s57 offen offset:1024 lds
    buffer_load_dwordx4 v10, s[32:35], s57 offen offset:2048 lds
    buffer_load_dwordx4 v11, s[32:35], s57 offen offset:3072 lds
    s_add_u32 m0, s4, 0
    s_add_u32 s57, s65, s58
    s_waitcnt vmcnt(12)
    s_barrier
    buffer_load_dwordx4 v8, s[32:35], s57 offen lds
    buffer_load_dwordx4 v9, s[32:35], s57 offen offset:1024 lds
    buffer_load_dwordx4 v10, s[32:35], s57 offen offset:2048 lds
    buffer_load_dwordx4 v11, s[32:35], s57 offen offset:3072 lds
    s_add_u32 m0, s4, 4096
    s_add_u32 s57, s65, s59
    s_waitcnt vmcnt(12)
    s_barrier
    buffer_load_dwordx4 v8, s[32:35], s57 offen lds
    buffer_load_dwordx4 v9, s[32:35], s57 offen offset:1024 lds
    buffer_load_dwordx4 v10, s[32:35], s57 offen offset:2048 lds
    buffer_load_dwordx4 v11, s[32:35], s57 offen offset:3072 lds
    s_add_u32 m0, s4, 8192
    s_add_u32 s57, s66, s58
    s_waitcnt vmcnt(12)
    s_barrier
    buffer_load_dwordx4 v8, s[32:35], s57 offen lds
    buffer_load_dwordx4 v9, s[32:35], s57 offen offset:1024 lds
    buffer_load_dwordx4 v10, s[32:35], s57 offen offset:2048 lds
    buffer_load_dwordx4 v11, s[32:35], s57 offen offset:3072 lds
    s_add_u32 m0, s4, 12288
    s_add_u32 s57, s3, 0
    s_and_b32 s57, s57, 3
    s_mul_i32 s57, s57, 57344
    s_add_u32 s57, s57, s46
    s_waitcnt vmcnt(12)
    s_barrier
    buffer_load_dwordx4 v16, s[36:39], s57 offen lds
    buffer_load_dwordx4 v17, s[36:39], s57 offen offset:1024 lds
    buffer_load_dwordx4 v18, s[36:39], s57 offen offset:2048 lds
    buffer_load_dwordx4 v19, s[36:39], s57 offen offset:3072 lds
    s_add_u32 m0, s4, 16384
    s_add_u32 s57, s66, s59
    s_waitcnt vmcnt(12)
    s_barrier
    buffer_load_dwordx4 v8, s[32:35], s57 offen lds
    buffer_load_dwordx4 v9, s[32:35], s57 offen offset:1024 lds
    buffer_load_dwordx4 v10, s[32:35], s57 offen offset:2048 lds
    buffer_load_dwordx4 v11, s[32:35], s57 offen offset:3072 lds
    s_add_u32 m0, s4, 20480
    s_add_u32 s56, s101, 0
    s_and_b32 s56, s56, 3
    s_lshl_b32 s56, s56, 18
    s_add_u32 s56, s56, s45
    s_add_u32 s57, s3, 0
    s_and_b32 s57, s57, 3
    s_lshl_b32 s57, s57, 7
    s_add_u32 s57, s57, s56
    s_waitcnt vmcnt(12)
    s_barrier
    buffer_load_dwordx4 v28, s[28:31], s57 offen lds
    buffer_load_dwordx4 v29, s[28:31], s57 offen offset:1024 lds
    buffer_load_dwordx4 v30, s[28:31], s57 offen offset:2048 lds
    buffer_load_dwordx4 v31, s[28:31], s57 offen offset:3072 lds
    s_waitcnt vmcnt(12)
    s_barrier
    s_waitcnt vmcnt(8)
    s_barrier
    s_add_u32 m0, s4, 0
    s_add_u32 s57, s3, 0
    s_and_b32 s57, s57, 3
    s_mul_i32 s57, s57, 57344
    s_add_u32 s57, s57, s46
    s_add_u32 s57, s57, 28672
    s_waitcnt vmcnt(4)
    s_barrier
    buffer_load_dwordx4 v16, s[36:39], s57 offen lds
    buffer_load_dwordx4 v17, s[36:39], s57 offen offset:1024 lds
    buffer_load_dwordx4 v18, s[36:39], s57 offen offset:2048 lds
    buffer_load_dwordx4 v19, s[36:39], s57 offen offset:3072 lds
    s_add_u32 m0, s4, 4096
    s_add_u32 s57, s3, 1
    s_and_b32 s57, s57, 3
    s_mul_i32 s57, s57, 57344
    s_add_u32 s57, s57, s46
    buffer_load_dwordx4 v16, s[36:39], s57 offen lds
    buffer_load_dwordx4 v17, s[36:39], s57 offen offset:1024 lds
    buffer_load_dwordx4 v18, s[36:39], s57 offen offset:2048 lds
    buffer_load_dwordx4 v19, s[36:39], s57 offen offset:3072 lds
    s_add_u32 m0, s4, 8192
    s_add_u32 s57, s3, 1
    s_and_b32 s57, s57, 3
    s_lshl_b32 s57, s57, 7
    s_add_u32 s57, s57, s56
    buffer_load_dwordx4 v28, s[28:31], s57 offen lds
    buffer_load_dwordx4 v29, s[28:31], s57 offen offset:1024 lds
    buffer_load_dwordx4 v30, s[28:31], s57 offen offset:2048 lds
    buffer_load_dwordx4 v31, s[28:31], s57 offen offset:3072 lds
    s_barrier
    s_cmp_eq_u32 s98, 7
    s_cbranch_scc1 L_ldone0
    s_add_u32 m0, s4, 12288
    s_add_u32 s57, s3, 1
    s_and_b32 s57, s57, 3
    s_mul_i32 s57, s57, 57344
    s_add_u32 s57, s57, s46
    s_add_u32 s57, s57, 28672
    s_waitcnt vmcnt(12)
    s_barrier
    buffer_load_dwordx4 v16, s[36:39], s57 offen lds
    buffer_load_dwordx4 v17, s[36:39], s57 offen offset:1024 lds
    buffer_load_dwordx4 v18, s[36:39], s57 offen offset:2048 lds
    buffer_load_dwordx4 v19, s[36:39], s57 offen offset:3072 lds
    s_add_u32 m0, s4, 16384
    s_add_u32 s57, s3, 2
    s_and_b32 s57, s57, 3
    s_lshl_b32 s57, s57, 7
    s_add_u32 s57, s57, s56
    s_waitcnt vmcnt(12)
    s_barrier
    buffer_load_dwordx4 v28, s[28:31], s57 offen lds
    buffer_load_dwordx4 v29, s[28:31], s57 offen offset:1024 lds
    buffer_load_dwordx4 v30, s[28:31], s57 offen offset:2048 lds
    buffer_load_dwordx4 v31, s[28:31], s57 offen offset:3072 lds
    s_add_u32 m0, s4, 20480
    s_add_u32 s57, s3, 2
    s_and_b32 s57, s57, 3
    s_mul_i32 s57, s57, 57344
    s_add_u32 s57, s57, s46
    s_waitcnt vmcnt(12)
    s_barrier
    buffer_load_dwordx4 v16, s[36:39], s57 offen lds
    buffer_load_dwordx4 v17, s[36:39], s57 offen offset:1024 lds
    buffer_load_dwordx4 v18, s[36:39], s57 offen offset:2048 lds
    buffer_load_dwordx4 v19, s[36:39], s57 offen offset:3072 lds
    s_add_u32 m0, s4, 0
    s_add_u32 s57, s3, 2
    s_and_b32 s57, s57, 3
    s_mul_i32 s57, s57, 57344
    s_add_u32 s57, s57, s46
    s_add_u32 s57, s57, 28672
    s_waitcnt vmcnt(12)
    s_barrier
    buffer_load_dwordx4 v16, s[36:39], s57 offen lds
    buffer_load_dwordx4 v17, s[36:39], s57 offen offset:1024 lds
    buffer_load_dwordx4 v18, s[36:39], s57 offen offset:2048 lds
    buffer_load_dwordx4 v19, s[36:39], s57 offen offset:3072 lds
    s_add_u32 m0, s4, 4096
    s_add_u32 s57, s3, 3
    s_and_b32 s57, s57, 3
    s_lshl_b32 s57, s57, 7
    s_add_u32 s57, s57, s56
    s_waitcnt vmcnt(12)
    s_barrier
    buffer_load_dwordx4 v28, s[28:31], s57 offen lds
    buffer_load_dwordx4 v29, s[28:31], s57 offen offset:1024 lds
    buffer_load_dwordx4 v30, s[28:31], s57 offen offset:2048 lds
    buffer_load_dwordx4 v31, s[28:31], s57 offen offset:3072 lds
    s_add_u32 m0, s4, 8192
    s_add_u32 s57, s3, 3
    s_and_b32 s57, s57, 3
    s_mul_i32 s57, s57, 57344
    s_add_u32 s57, s57, s46
    s_waitcnt vmcnt(12)
    s_barrier
    buffer_load_dwordx4 v16, s[36:39], s57 offen lds
    buffer_load_dwordx4 v17, s[36:39], s57 offen offset:1024 lds
    buffer_load_dwordx4 v18, s[36:39], s57 offen offset:2048 lds
    buffer_load_dwordx4 v19, s[36:39], s57 offen offset:3072 lds
    s_add_u32 m0, s4, 12288
    s_add_u32 s57, s3, 3
    s_and_b32 s57, s57, 3
    s_mul_i32 s57, s57, 57344
    s_add_u32 s57, s57, s46
    s_add_u32 s57, s57, 28672
    s_waitcnt vmcnt(12)
    s_barrier
    buffer_load_dwordx4 v16, s[36:39], s57 offen lds
    buffer_load_dwordx4 v17, s[36:39], s57 offen offset:1024 lds
    buffer_load_dwordx4 v18, s[36:39], s57 offen offset:2048 lds
    buffer_load_dwordx4 v19, s[36:39], s57 offen offset:3072 lds
    s_add_u32 m0, s4, 16384
    s_add_u32 s56, s101, 1
    s_and_b32 s56, s56, 3
    s_lshl_b32 s56, s56, 18
    s_add_u32 s56, s56, s45
    s_add_u32 s57, s3, 0
    s_and_b32 s57, s57, 3
    s_lshl_b32 s57, s57, 7
    s_add_u32 s57, s57, s56
    s_waitcnt vmcnt(12)
    s_barrier
    buffer_load_dwordx4 v28, s[28:31], s57 offen lds
    buffer_load_dwordx4 v29, s[28:31], s57 offen offset:1024 lds
    buffer_load_dwordx4 v30, s[28:31], s57 offen offset:2048 lds
    buffer_load_dwordx4 v31, s[28:31], s57 offen offset:3072 lds
    s_add_u32 m0, s4, 20480
    s_add_u32 s57, s3, 1
    s_and_b32 s57, s57, 3
    s_lshl_b32 s57, s57, 7
    s_add_u32 s57, s57, s56
    s_waitcnt vmcnt(12)
    s_barrier
    buffer_load_dwordx4 v28, s[28:31], s57 offen lds
    buffer_load_dwordx4 v29, s[28:31], s57 offen offset:1024 lds
    buffer_load_dwordx4 v30, s[28:31], s57 offen offset:2048 lds
    buffer_load_dwordx4 v31, s[28:31], s57 offen offset:3072 lds
    s_lshl_b32 s57, s49, 11
    s_add_u32 m0, s57, 122880
    s_add_u32 s57, s101, 0
    s_and_b32 s57, s57, 3
    s_lshl_b32 s57, s57, 15
    s_add_u32 s57, s57, s6
    buffer_load_dwordx4 v20, s[40:43], s57 offen sc1 lds
    buffer_load_dwordx4 v20, s[40:43], s57 offen offset:1024 sc1 lds
    s_lshl_b32 s57, s49, 11
    s_add_u32 m0, s57, 131072
    s_add_u32 s57, s101, 1
    s_and_b32 s57, s57, 3
    s_lshl_b32 s57, s57, 15
    s_add_u32 s57, s57, s6
    buffer_load_dwordx4 v20, s[40:43], s57 offen sc1 lds
    buffer_load_dwordx4 v20, s[40:43], s57 offen offset:1024 sc1 lds
    s_lshl_b32 s57, s49, 11
    s_add_u32 m0, s57, 139264
    s_add_u32 s57, s101, 2
    s_and_b32 s57, s57, 3
    s_lshl_b32 s57, s57, 15
    s_add_u32 s57, s57, s6
    buffer_load_dwordx4 v20, s[40:43], s57 offen sc1 lds
    buffer_load_dwordx4 v20, s[40:43], s57 offen offset:1024 sc1 lds
    s_lshl_b32 s57, s49, 11
    s_add_u32 m0, s57, 147456
    s_add_u32 s57, s101, 3
    s_and_b32 s57, s57, 3
    s_lshl_b32 s57, s57, 15
    s_add_u32 s57, s57, s6
    buffer_load_dwordx4 v20, s[40:43], s57 offen sc1 lds
    buffer_load_dwordx4 v20, s[40:43], s57 offen offset:1024 sc1 lds
    s_add_u32 m0, s4, 0
    s_add_u32 s57, s3, 2
    s_and_b32 s57, s57, 3
    s_lshl_b32 s57, s57, 7
    s_add_u32 s57, s57, s56
    s_waitcnt vmcnt(20)
    s_barrier
    buffer_load_dwordx4 v28, s[28:31], s57 offen lds
    buffer_load_dwordx4 v29, s[28:31], s57 offen offset:1024 lds
    buffer_load_dwordx4 v30, s[28:31], s57 offen offset:2048 lds
    buffer_load_dwordx4 v31, s[28:31], s57 offen offset:3072 lds
    s_waitcnt vmcnt(20)
    s_barrier
    s_waitcnt vmcnt(16)
    s_barrier
    s_add_u32 m0, s4, 4096
    s_add_u32 s57, s3, 3
    s_and_b32 s57, s57, 3
    s_lshl_b32 s57, s57, 7
    s_add_u32 s57, s57, s56
    s_waitcnt vmcnt(4)
    s_barrier
    buffer_load_dwordx4 v28, s[28:31], s57 offen lds
    buffer_load_dwordx4 v29, s[28:31], s57 offen offset:1024 lds
    buffer_load_dwordx4 v30, s[28:31], s57 offen offset:2048 lds
    buffer_load_dwordx4 v31, s[28:31], s57 offen offset:3072 lds
    s_add_u32 m0, s4, 8192
    s_add_u32 s56, s101, 2
    s_and_b32 s56, s56, 3
    s_lshl_b32 s56, s56, 18
    s_add_u32 s56, s56, s45
    s_add_u32 s57, s3, 0
    s_and_b32 s57, s57, 3
    s_lshl_b32 s57, s57, 7
    s_add_u32 s57, s57, s56
    s_waitcnt vmcnt(4)
    s_barrier
    buffer_load_dwordx4 v28, s[28:31], s57 offen lds
    buffer_load_dwordx4 v29, s[28:31], s57 offen offset:1024 lds
    buffer_load_dwordx4 v30, s[28:31], s57 offen offset:2048 lds
    buffer_load_dwordx4 v31, s[28:31], s57 offen offset:3072 lds
    s_add_u32 m0, s4, 12288
    s_add_u32 s57, s3, 1
    s_and_b32 s57, s57, 3
    s_lshl_b32 s57, s57, 7
    s_add_u32 s57, s57, s56
    s_waitcnt vmcnt(4)
    s_barrier
    buffer_load_dwordx4 v28, s[28:31], s57 offen lds
    buffer_load_dwordx4 v29, s[28:31], s57 offen offset:1024 lds
    buffer_load_dwordx4 v30, s[28:31], s57 offen offset:2048 lds
    buffer_load_dwordx4 v31, s[28:31], s57 offen offset:3072 lds
    s_add_u32 m0, s4, 16384
    s_add_u32 s57, s3, 2
    s_and_b32 s57, s57, 3
    s_lshl_b32 s57, s57, 7
    s_add_u32 s57, s57, s56
    s_waitcnt vmcnt(4)
    s_barrier
    buffer_load_dwordx4 v28, s[28:31], s57 offen lds
    buffer_load_dwordx4 v29, s[28:31], s57 offen offset:1024 lds
    buffer_load_dwordx4 v30, s[28:31], s57 offen offset:2048 lds
    buffer_load_dwordx4 v31, s[28:31], s57 offen offset:3072 lds
    s_add_u32 m0, s4, 20480
    s_add_u32 s57, s3, 3
    s_and_b32 s57, s57, 3
    s_lshl_b32 s57, s57, 7
    s_add_u32 s57, s57, s56
    s_waitcnt vmcnt(4)
    s_barrier
    buffer_load_dwordx4 v28, s[28:31], s57 offen lds
    buffer_load_dwordx4 v29, s[28:31], s57 offen offset:1024 lds
    buffer_load_dwordx4 v30, s[28:31], s57 offen offset:2048 lds
    buffer_load_dwordx4 v31, s[28:31], s57 offen offset:3072 lds
    s_add_u32 m0, s4, 0
    s_add_u32 s56, s101, 3
    s_and_b32 s56, s56, 3
    s_lshl_b32 s56, s56, 18
    s_add_u32 s56, s56, s45
    s_add_u32 s57, s3, 0
    s_and_b32 s57, s57, 3
    s_lshl_b32 s57, s57, 7
    s_add_u32 s57, s57, s56
    s_waitcnt vmcnt(4)
    s_barrier
    buffer_load_dwordx4 v28, s[28:31], s57 offen lds
    buffer_load_dwordx4 v29, s[28:31], s57 offen offset:1024 lds
    buffer_load_dwordx4 v30, s[28:31], s57 offen offset:2048 lds
    buffer_load_dwordx4 v31, s[28:31], s57 offen offset:3072 lds
    s_add_u32 m0, s4, 4096
    s_add_u32 s57, s3, 1
    s_and_b32 s57, s57, 3
    s_lshl_b32 s57, s57, 7
    s_add_u32 s57, s57, s56
    buffer_load_dwordx4 v28, s[28:31], s57 offen lds
    buffer_load_dwordx4 v29, s[28:31], s57 offen offset:1024 lds
    buffer_load_dwordx4 v30, s[28:31], s57 offen offset:2048 lds
    buffer_load_dwordx4 v31, s[28:31], s57 offen offset:3072 lds
    s_add_u32 m0, s4, 8192
    s_add_u32 s57, s3, 2
    s_and_b32 s57, s57, 3
    s_lshl_b32 s57, s57, 7
    s_add_u32 s57, s57, s56
    s_waitcnt vmcnt(8)
    s_barrier
    buffer_load_dwordx4 v28, s[28:31], s57 offen lds
    buffer_load_dwordx4 v29, s[28:31], s57 offen offset:1024 lds
    buffer_load_dwordx4 v30, s[28:31], s57 offen offset:2048 lds
    buffer_load_dwordx4 v31, s[28:31], s57 offen offset:3072 lds
    s_add_u32 m0, s4, 12288
    s_add_u32 s57, s3, 3
    s_and_b32 s57, s57, 3
    s_lshl_b32 s57, s57, 7
    s_add_u32 s57, s57, s56
    buffer_load_dwordx4 v28, s[28:31], s57 offen lds
    buffer_load_dwordx4 v29, s[28:31], s57 offen offset:1024 lds
    buffer_load_dwordx4 v30, s[28:31], s57 offen offset:2048 lds
    buffer_load_dwordx4 v31, s[28:31], s57 offen offset:3072 lds
    s_waitcnt vmcnt(12)
    s_barrier
    s_waitcnt vmcnt(8)
    s_barrier
    s_waitcnt vmcnt(4)
    s_barrier
    s_waitcnt vmcnt(0)
    s_barrier
L_ldone0:
    s_endpgm
L_loader1:
    s_add_u32 m0, s4, 8192
    s_add_u32 s57, s61, s58
    s_waitcnt vmcnt(12)
    s_barrier
    buffer_load_dwordx4 v8, s[32:35], s57 offen lds
    buffer_load_dwordx4 v9, s[32:35], s57 offen offset:1024 lds
    buffer_load_dwordx4 v10, s[32:35], s57 offen offset:2048 lds
    buffer_load_dwordx4 v11, s[32:35], s57 offen offset:3072 lds
    s_add_u32 m0, s4, 12288
    s_add_u32 s57, s61, s59
    s_waitcnt vmcnt(12)
    s_barrier
    buffer_load_dwordx4 v8, s[32:35], s57 offen lds
    buffer_load_dwordx4 v9, s[32:35], s57 offen offset:1024 lds
    buffer_load_dwordx4 v10, s[32:35], s57 offen offset:2048 lds
    buffer_load_dwordx4 v11, s[32:35], s57 offen offset:3072 lds
    s_add_u32 m0, s4, 16384
    s_add_u32 s57, s62, s58
    s_waitcnt vmcnt(12)
    s_barrier
    buffer_load_dwordx4 v8, s[32:35], s57 offen lds
    buffer_load_dwordx4 v9, s[32:35], s57 offen offset:1024 lds
    buffer_load_dwordx4 v10, s[32:35], s57 offen offset:2048 lds
    buffer_load_dwordx4 v11, s[32:35], s57 offen offset:3072 lds
    s_add_u32 m0, s4, 20480
    s_add_u32 s57, s62, s59
    s_waitcnt vmcnt(12)
    s_barrier
    buffer_load_dwordx4 v8, s[32:35], s57 offen lds
    buffer_load_dwordx4 v9, s[32:35], s57 offen offset:1024 lds
    buffer_load_dwordx4 v10, s[32:35], s57 offen offset:2048 lds
    buffer_load_dwordx4 v11, s[32:35], s57 offen offset:3072 lds
    s_add_u32 m0, s5, 16384
    s_nop 0
    s_waitcnt vmcnt(12)
    s_barrier
    buffer_load_dwordx4 v4, s[20:23], s69 offen lds
    buffer_load_dwordx4 v5, s[20:23], s69 offen offset:1024 lds
    buffer_load_dwordx4 v6, s[20:23], s69 offen offset:2048 lds
    buffer_load_dwordx4 v7, s[20:23], s69 offen offset:3072 lds
    s_add_u32 m0, s4, 0
    s_add_u32 s57, s44, 0
    s_waitcnt vmcnt(12)
    s_barrier
    buffer_load_dwordx4 v12, s[24:27], s57 offen lds
    buffer_load_dwordx4 v13, s[24:27], s57 offen offset:1024 lds
    buffer_load_dwordx4 v14, s[24:27], s57 offen offset:2048 lds
    buffer_load_dwordx4 v15, s[24:27], s57 offen offset:3072 lds
    s_add_u32 m0, s4, 4096
    s_add_u32 s57, s44, 128
    s_waitcnt vmcnt(12)
    s_barrier
    buffer_load_dwordx4 v12, s[24:27], s57 offen lds
    buffer_load_dwordx4 v13, s[24:27], s57 offen offset:1024 lds
    buffer_load_dwordx4 v14, s[24:27], s57 offen offset:2048 lds
    buffer_load_dwordx4 v15, s[24:27], s57 offen offset:3072 lds
    s_add_u32 m0, s4, 8192
    s_add_u32 s57, s63, s58
    s_waitcnt vmcnt(12)
    s_branch L_ljoin
.p2align 12
.fill 614, 4, 0xbf810000
L_compute:
    s_load_dwordx2 s[44:45], s[0:1], 40
    s_load_dwordx2 s[24:25], s[0:1], 48
    s_and_b32 s49, s48, 3
    s_lshr_b32 s52, s2, 4
    s_bfe_u32 s51, s2, 0x10003
    s_mul_i32 s55, s52, 7
    s_mul_i32 s54, s51, 3
    s_lshr_b32 s57, s55, 4
    s_bfe_u32 s56, s55, 0x10003
    s_add_u32 s57, s57, s54
    s_and_b32 s50, s2, 7
    s_lshr_b32 s55, s2, 3
    s_mul_i32 s99, s55, 37
    s_lshr_b32 s99, s99, 8
    s_mul_i32 s98, s99, 7
    s_sub_u32 s98, s55, s98
    s_cmp_ge_u32 s55, 28
    s_cselect_b32 s99, s98, s99
    s_cselect_b32 s98, 7, s98
    s_and_b32 s100, s50, 4
    s_add_u32 s100, s100, s99
    s_add_u32 s101, s50, s98
    s_add_u32 s101, s101, 1
    s_and_b32 s101, s101, 3
    s_lshr_b32 s3, s98, 2
    s_lshl_b32 s3, s3, 1
    s_add_u32 s3, s3, s99
    s_and_b32 s3, s3, 3
    s_lshl_b32 s53, s50, 1
    s_add_u32 s53, s53, s51
    v_bfe_u32 v1, v0, 1, 3
    v_lshrrev_b32 v2, 5, v0
    v_xor_b32 v2, v1, v2
    v_lshlrev_b32 v2, 4, v2
    v_and_b32 v3, 31, v0
    v_lshl_add_u32 v2, v3, 7, v2
    s_mul_i32 s54, s49, 24576
    v_add_u32 v22, s54, v2
    v_xor_b32 v23, 32, v22
    v_xor_b32 v24, 64, v22
    v_xor_b32 v25, 96, v22
    v_lshrrev_b32 v2, 4, v0
    v_xor_b32 v1, v1, v2
    v_lshlrev_b32 v1, 4, v1
    v_and_b32 v3, 15, v0
    v_lshl_add_u32 v1, v3, 7, v1
    s_and_b32 s63, s49, 2
    s_mul_i32 s63, s63, 24576
    v_add_u32 v4, s63, v1
    v_xor_b32 v5, 64, v4
    s_lshl_b32 s55, s56, 6
    v_xor_b32 v1, s55, v1
    s_and_b32 s57, s49, 1
    s_lshl_b32 s55, s57, 12
    s_add_u32 s55, s55, 98304
    v_add_u32 v16, s55, v1
    v_xor_b32 v17, 64, v16
    v_lshlrev_b32 v1, 10, v2
    v_and_b32 v2, 1, v2
    v_lshl_add_u32 v1, v2, 6, v1
    v_bfe_u32 v2, v0, 2, 2
    v_lshl_add_u32 v1, v2, 7, v1
    v_lshrrev_b32 v2, 1, v2
    v_lshl_add_u32 v1, v2, 5, v1
    v_and_b32 v2, 3, v0
    v_lshl_add_u32 v1, v2, 3, v1
    v_add_u32 v18, s63, v1
    v_xor_b32 v19, 32, v18
    v_xor_b32 v20, 64, v18
    v_xor_b32 v21, 96, v18
    s_lshl_b32 s55, s57, 1
    s_lshr_b32 s56, s49, 1
    s_add_u32 s63, s55, s56
    s_lshl_b32 s55, s63, 5
    v_xor_b32 v12, s55, v18
    v_xor_b32 v13, 32, v12
    v_lshlrev_b32 v11, 4, v0
    s_lshl_b32 s54, s49, 11
    s_add_u32 s54, s54, 106496
    s_mov_b32 s6, s54
    s_xor_b32 s7, s54, 4096
    s_lshl_b32 s8, s56, 12
    s_add_u32 s8, s8, 122880
    s_lshl_b32 s69, s52, 1
    s_add_u32 s69, s69, s57
    s_lshl_b32 s69, s69, 4
    s_add_u32 s69, s69, s53
    s_lshl_b32 s69, s69, 11
    s_add_u32 s69, s69, 1048576
    s_and_b32 s54, s50, 3
    s_lshl_b32 s59, s100, 4
    s_add_u32 s59, s59, s54
    s_lshl_b32 s59, s59, 1
    s_add_u32 s59, s59, s56
    s_lshl_b32 s59, s59, 12
    s_add_u32 s59, s59, 1048576
    s_mul_i32 s58, s100, 7
    s_add_u32 s58, s58, s98
    s_mul_i32 s58, s58, 98304
    s_lshl_b32 s54, s63, 11
    s_add_u32 s58, s58, s54
    s_add_u32 s58, s58, 2097152
    s_add_u32 s55, s101, 3
    s_and_b32 s55, s55, 3
    s_mul_i32 s4, s55, 24576
    s_add_u32 s4, s4, s58
    s_lshl_b32 s5, s100, 2
    s_add_u32 s5, s5, s55
    s_mul_i32 s5, s5, 28672
    s_lshl_b32 s54, s98, 7
    s_add_u32 s5, s5, s54
    s_lshl_b32 s54, s63, 5
    s_add_u32 s5, s5, s54
    s_add_u32 s54, s101, 0
    s_and_b32 s54, s54, 3
    s_mul_i32 s54, s54, 24576
    s_add_u32 s54, s54, s58
    s_add_u32 s12, s54, 0
    s_add_u32 s15, s4, 0
    s_add_u32 s54, s101, 1
    s_and_b32 s54, s54, 3
    s_mul_i32 s54, s54, 24576
    s_add_u32 s54, s54, s58
    s_add_u32 s13, s54, 8192
    s_add_u32 s16, s4, 8192
    s_add_u32 s54, s101, 2
    s_and_b32 s54, s54, 3
    s_mul_i32 s54, s54, 24576
    s_add_u32 s54, s54, s58
    s_add_u32 s14, s54, 16384
    s_add_u32 s17, s4, 16384
    s_mov_b32 s60, 0xffffff00
    s_mov_b32 s61, 0x3fff3fff
    s_mov_b32 s62, 0x3db8aa3b
    v_mov_b32 v10, 0
    s_lshl_b32 s54, s57, 12
    s_add_u32 s54, s54, 98304
    v_add_u32 v9, s54, v11
    v_mov_b32 v3, v11
    s_waitcnt lgkmcnt(0)
    s_mov_b32 s42, 7602176
    s_mov_b32 s43, 0x00020000
    s_mov_b32 s26, 256
    s_mov_b32 s27, 0x00020000
    s_mov_b32 s46, 917504
    s_mov_b32 s47, 0x00020000
    s_cmp_eq_u32 s49, 1
    s_cbranch_scc0 L_nopf
    s_getpc_b64 s[10:11]
L_pc:
    s_sub_u32 s10, s10, L_pc-standalone__mha_block_cached__near_ridge_kernel
    s_subb_u32 s11, s11, 0
    s_lshr_b32 s54, s2, 3
    s_lshl_b32 s54, s54, 10
    v_add_u32 v0, s54, v3
    v_min_u32 v0, L_end-standalone__mha_block_cached__near_ridge_kernel-12, v0
    global_load_dwordx4 v[192:195], v0, s[10:11]
L_nopf:
    s_lshl_b32 s54, s49, 8
    s_or_b32 s54, s54, s2
    s_cmp_eq_u32 s54, 248
    s_cbranch_scc0 L_notlead
    buffer_load_dwordx4 v[32:35], v10, s[40:43], 0 offen sc1
    s_waitcnt vmcnt(0)
    v_xor_b32 v32, 0xc000c0ff, v32
    v_xor_b32 v34, 0xc000c000, v34
    v_or_b32 v32, 0x100, v32
    buffer_store_dwordx4 v[32:35], v10, s[24:27], 0 offen sc1
    buffer_store_dwordx4 v[32:35], v10, s[40:43], 0 offen sc1
L_notlead:
    s_bitcmp1_b32 s2, 3
    s_cbranch_scc1 L_cls1
L_comp0:
    s_barrier
    s_barrier
    ds_read_b128 v[128:131], v16 offset:0
    ds_read_b128 v[132:135], v16 offset:2048
    ds_read_b64_tr_b16 v[96:97], v18 offset:0
    ds_read_b64_tr_b16 v[98:99], v18 offset:512
    ds_read_b64_tr_b16 v[100:101], v19 offset:0
    ds_read_b64_tr_b16 v[102:103], v19 offset:512
    ds_read_b64_tr_b16 v[104:105], v20 offset:0
    ds_read_b64_tr_b16 v[106:107], v20 offset:512
    ds_read_b64_tr_b16 v[108:109], v21 offset:0
    ds_read_b64_tr_b16 v[110:111], v21 offset:512
    ds_read_b64_tr_b16 v[112:113], v18 offset:24576
    ds_read_b64_tr_b16 v[114:115], v18 offset:25088
    ds_read_b64_tr_b16 v[116:117], v19 offset:24576
    ds_read_b64_tr_b16 v[118:119], v19 offset:25088
    ds_read_b64_tr_b16 v[120:121], v20 offset:24576
    ds_read_b64_tr_b16 v[122:123], v20 offset:25088
    ds_read_b64_tr_b16 v[124:125], v21 offset:24576
    ds_read_b64_tr_b16 v[126:127], v21 offset:25088
    s_barrier
    s_waitcnt lgkmcnt(12)
    v_mfma_f32_16x16x32_bf16 v[32:35], v[96:99], v[128:131], 0
    ds_read_b128 v[136:139], v17 offset:0
    v_mfma_f32_16x16x32_bf16 v[36:39], v[96:99], v[132:135], 0
    v_mfma_f32_16x16x32_bf16 v[40:43], v[100:103], v[128:131], 0
    ds_read_b128 v[140:143], v17 offset:2048
    ds_read_b64_tr_b16 v[96:97], v18 offset:4096
    v_mfma_f32_16x16x32_bf16 v[44:47], v[100:103], v[132:135], 0
    ds_read_b64_tr_b16 v[98:99], v18 offset:4608
    s_waitcnt lgkmcnt(12)
    v_mfma_f32_16x16x32_bf16 v[48:51], v[104:107], v[128:131], 0
    ds_read_b64_tr_b16 v[100:101], v19 offset:4096
    v_mfma_f32_16x16x32_bf16 v[52:55], v[104:107], v[132:135], 0
    ds_read_b64_tr_b16 v[102:103], v19 offset:4608
    v_mfma_f32_16x16x32_bf16 v[56:59], v[108:111], v[128:131], 0
    ds_read_b64_tr_b16 v[104:105], v20 offset:4096
    v_mfma_f32_16x16x32_bf16 v[60:63], v[108:111], v[132:135], 0
    ds_read_b64_tr_b16 v[106:107], v20 offset:4608
    s_waitcnt lgkmcnt(12)
    v_mfma_f32_16x16x32_bf16 v[64:67], v[112:115], v[128:131], 0
    ds_read_b64_tr_b16 v[108:109], v21 offset:4096
    v_mfma_f32_16x16x32_bf16 v[68:71], v[112:115], v[132:135], 0
    ds_read_b64_tr_b16 v[110:111], v21 offset:4608
    v_mfma_f32_16x16x32_bf16 v[72:75], v[116:119], v[128:131], 0
    ds_read_b64_tr_b16 v[112:113], v18 offset:28672
    v_mfma_f32_16x16x32_bf16 v[76:79], v[116:119], v[132:135], 0
    ds_read_b64_tr_b16 v[114:115], v18 offset:29184
    s_waitcnt lgkmcnt(12)
    v_mfma_f32_16x16x32_bf16 v[80:83], v[120:123], v[128:131], 0
    ds_read_b64_tr_b16 v[116:117], v19 offset:28672
    v_mfma_f32_16x16x32_bf16 v[84:87], v[120:123], v[132:135], 0
    ds_read_b64_tr_b16 v[118:119], v19 offset:29184
    v_mfma_f32_16x16x32_bf16 v[88:91], v[124:127], v[128:131], 0
    ds_read_b64_tr_b16 v[120:121], v20 offset:28672
    v_mfma_f32_16x16x32_bf16 v[92:95], v[124:127], v[132:135], 0
    ds_read_b64_tr_b16 v[122:123], v20 offset:29184
    s_barrier
    s_waitcnt lgkmcnt(10)
    v_mfma_f32_16x16x32_bf16 v[32:35], v[96:99], v[136:139], v[32:35]
    ds_read_b64_tr_b16 v[124:125], v21 offset:28672
    v_mfma_f32_16x16x32_bf16 v[36:39], v[96:99], v[140:143], v[36:39]
    ds_read_b64_tr_b16 v[126:127], v21 offset:29184
    v_mfma_f32_16x16x32_bf16 v[40:43], v[100:103], v[136:139], v[40:43]
    v_mfma_f32_16x16x32_bf16 v[44:47], v[100:103], v[140:143], v[44:47]
    s_waitcnt lgkmcnt(8)
    v_mfma_f32_16x16x32_bf16 v[48:51], v[104:107], v[136:139], v[48:51]
    v_mfma_f32_16x16x32_bf16 v[52:55], v[104:107], v[140:143], v[52:55]
    v_mfma_f32_16x16x32_bf16 v[56:59], v[108:111], v[136:139], v[56:59]
    v_mfma_f32_16x16x32_bf16 v[60:63], v[108:111], v[140:143], v[60:63]
    s_waitcnt lgkmcnt(4)
    v_mfma_f32_16x16x32_bf16 v[64:67], v[112:115], v[136:139], v[64:67]
    v_mfma_f32_16x16x32_bf16 v[68:71], v[112:115], v[140:143], v[68:71]
    v_mfma_f32_16x16x32_bf16 v[72:75], v[116:119], v[136:139], v[72:75]
    v_mfma_f32_16x16x32_bf16 v[76:79], v[116:119], v[140:143], v[76:79]
    s_waitcnt lgkmcnt(0)
    v_mfma_f32_16x16x32_bf16 v[80:83], v[120:123], v[136:139], v[80:83]
    v_mfma_f32_16x16x32_bf16 v[84:87], v[120:123], v[140:143], v[84:87]
    v_mfma_f32_16x16x32_bf16 v[88:91], v[124:127], v[136:139], v[88:91]
    v_mfma_f32_16x16x32_bf16 v[92:95], v[124:127], v[140:143], v[92:95]
    s_barrier
    ds_read_b128 v[160:163], v22 offset:8192
    ds_read_b128 v[164:167], v23 offset:8192
    ds_read_b128 v[168:171], v24 offset:8192
    ds_read_b128 v[172:175], v25 offset:8192
    s_barrier
    ds_read_b128 v[176:179], v22 offset:12288
    ds_read_b128 v[180:183], v23 offset:12288
    ds_read_b128 v[184:187], v24 offset:12288
    ds_read_b128 v[188:191], v25 offset:12288
    s_waitcnt lgkmcnt(4)
    s_barrier
    ds_read_b128 v[128:131], v16 offset:8192
    ds_read_b128 v[132:135], v16 offset:10240
    ds_read_b64_tr_b16 v[96:97], v18 offset:16384
    ds_read_b64_tr_b16 v[98:99], v18 offset:16896
    ds_read_b64_tr_b16 v[100:101], v19 offset:16384
    ds_read_b64_tr_b16 v[102:103], v19 offset:16896
    ds_read_b64_tr_b16 v[104:105], v20 offset:16384
    ds_read_b64_tr_b16 v[106:107], v20 offset:16896
    ds_read_b64_tr_b16 v[108:109], v21 offset:16384
    ds_read_b64_tr_b16 v[110:111], v21 offset:16896
    ds_read_b64_tr_b16 v[112:113], v18 offset:40960
    ds_read_b64_tr_b16 v[114:115], v18 offset:41472
    ds_read_b64_tr_b16 v[116:117], v19 offset:40960
    ds_read_b64_tr_b16 v[118:119], v19 offset:41472
    ds_read_b64_tr_b16 v[120:121], v20 offset:40960
    ds_read_b64_tr_b16 v[122:123], v20 offset:41472
    ds_read_b64_tr_b16 v[124:125], v21 offset:40960
    ds_read_b64_tr_b16 v[126:127], v21 offset:41472
    s_waitcnt lgkmcnt(15)
    s_barrier
    s_waitcnt lgkmcnt(12)
    v_mfma_f32_16x16x32_bf16 v[32:35], v[96:99], v[128:131], v[32:35]
    ds_read_b128 v[136:139], v17 offset:8192
    v_mfma_f32_16x16x32_bf16 v[36:39], v[96:99], v[132:135], v[36:39]
    v_mfma_f32_16x16x32_bf16 v[40:43], v[100:103], v[128:131], v[40:43]
    ds_read_b128 v[140:143], v17 offset:10240
    ds_read_b64_tr_b16 v[96:97], v18 offset:20480
    v_mfma_f32_16x16x32_bf16 v[44:47], v[100:103], v[132:135], v[44:47]
    ds_read_b64_tr_b16 v[98:99], v18 offset:20992
    s_waitcnt lgkmcnt(12)
    v_mfma_f32_16x16x32_bf16 v[48:51], v[104:107], v[128:131], v[48:51]
    ds_read_b64_tr_b16 v[100:101], v19 offset:20480
    v_mfma_f32_16x16x32_bf16 v[52:55], v[104:107], v[132:135], v[52:55]
    ds_read_b64_tr_b16 v[102:103], v19 offset:20992
    v_mfma_f32_16x16x32_bf16 v[56:59], v[108:111], v[128:131], v[56:59]
    ds_read_b64_tr_b16 v[104:105], v20 offset:20480
    v_mfma_f32_16x16x32_bf16 v[60:63], v[108:111], v[132:135], v[60:63]
    ds_read_b64_tr_b16 v[106:107], v20 offset:20992
    s_waitcnt lgkmcnt(12)
    v_mfma_f32_16x16x32_bf16 v[64:67], v[112:115], v[128:131], v[64:67]
    ds_read_b64_tr_b16 v[108:109], v21 offset:20480
    v_mfma_f32_16x16x32_bf16 v[68:71], v[112:115], v[132:135], v[68:71]
    ds_read_b64_tr_b16 v[110:111], v21 offset:20992
    v_mfma_f32_16x16x32_bf16 v[72:75], v[116:119], v[128:131], v[72:75]
    ds_read_b64_tr_b16 v[112:113], v18 offset:45056
    v_mfma_f32_16x16x32_bf16 v[76:79], v[116:119], v[132:135], v[76:79]
    ds_read_b64_tr_b16 v[114:115], v18 offset:45568
    s_waitcnt lgkmcnt(12)
    v_mfma_f32_16x16x32_bf16 v[80:83], v[120:123], v[128:131], v[80:83]
    ds_read_b64_tr_b16 v[116:117], v19 offset:45056
    v_mfma_f32_16x16x32_bf16 v[84:87], v[120:123], v[132:135], v[84:87]
    ds_read_b64_tr_b16 v[118:119], v19 offset:45568
    v_mfma_f32_16x16x32_bf16 v[88:91], v[124:127], v[128:131], v[88:91]
    ds_read_b64_tr_b16 v[120:121], v20 offset:45056
    v_mfma_f32_16x16x32_bf16 v[92:95], v[124:127], v[132:135], v[92:95]
    ds_read_b64_tr_b16 v[122:123], v20 offset:45568
    s_barrier
    s_waitcnt lgkmcnt(10)
    v_mfma_f32_16x16x32_bf16 v[32:35], v[96:99], v[136:139], v[32:35]
    ds_read_b64_tr_b16 v[124:125], v21 offset:45056
    ds_read_b64_tr_b16 v[126:127], v21 offset:45568
    v_mfma_f32_16x16x32_bf16 v[36:39], v[96:99], v[140:143], v[36:39]
    ds_read_b128 v[128:131], v16 offset:16384
    v_mfma_f32_16x16x32_bf16 v[40:43], v[100:103], v[136:139], v[40:43]
    ds_read_b128 v[132:135], v16 offset:18432
    ds_read_b64_tr_b16 v[96:97], v18 offset:0
    v_mfma_f32_16x16x32_bf16 v[44:47], v[100:103], v[140:143], v[44:47]
    ds_read_b64_tr_b16 v[98:99], v18 offset:512
    s_waitcnt lgkmcnt(12)
    v_mfma_f32_16x16x32_bf16 v[48:51], v[104:107], v[136:139], v[48:51]
    ds_read_b64_tr_b16 v[100:101], v19 offset:0
    v_mfma_f32_16x16x32_bf16 v[52:55], v[104:107], v[140:143], v[52:55]
    ds_read_b64_tr_b16 v[102:103], v19 offset:512
    v_mfma_f32_16x16x32_bf16 v[56:59], v[108:111], v[136:139], v[56:59]
    ds_read_b64_tr_b16 v[104:105], v20 offset:0
    v_mfma_f32_16x16x32_bf16 v[60:63], v[108:111], v[140:143], v[60:63]
    ds_read_b64_tr_b16 v[106:107], v20 offset:512
    s_waitcnt lgkmcnt(12)
    v_mfma_f32_16x16x32_bf16 v[64:67], v[112:115], v[136:139], v[64:67]
    ds_read_b64_tr_b16 v[108:109], v21 offset:0
    v_mfma_f32_16x16x32_bf16 v[68:71], v[112:115], v[140:143], v[68:71]
    ds_read_b64_tr_b16 v[110:111], v21 offset:512
    v_mfma_f32_16x16x32_bf16 v[72:75], v[116:119], v[136:139], v[72:75]
    ds_read_b64_tr_b16 v[112:113], v18 offset:24576
    v_mfma_f32_16x16x32_bf16 v[76:79], v[116:119], v[140:143], v[76:79]
    ds_read_b64_tr_b16 v[114:115], v18 offset:25088
    s_waitcnt lgkmcnt(12)
    v_mfma_f32_16x16x32_bf16 v[80:83], v[120:123], v[136:139], v[80:83]
    ds_read_b64_tr_b16 v[116:117], v19 offset:24576
    v_mfma_f32_16x16x32_bf16 v[84:87], v[120:123], v[140:143], v[84:87]
    ds_read_b64_tr_b16 v[118:119], v19 offset:25088
    v_mfma_f32_16x16x32_bf16 v[88:91], v[124:127], v[136:139], v[88:91]
    ds_read_b64_tr_b16 v[120:121], v20 offset:24576
    v_mfma_f32_16x16x32_bf16 v[92:95], v[124:127], v[140:143], v[92:95]
    ds_read_b64_tr_b16 v[122:123], v20 offset:25088
    s_barrier
    s_waitcnt lgkmcnt(10)
    v_mfma_f32_16x16x32_bf16 v[32:35], v[96:99], v[128:131], v[32:35]
    ds_read_b64_tr_b16 v[124:125], v21 offset:24576
    ds_read_b64_tr_b16 v[126:127], v21 offset:25088
    v_mfma_f32_16x16x32_bf16 v[36:39], v[96:99], v[132:135], v[36:39]
    ds_read_b128 v[136:139], v17 offset:16384
    v_mfma_f32_16x16x32_bf16 v[40:43], v[100:103], v[128:131], v[40:43]
    ds_read_b128 v[140:143], v17 offset:18432
    ds_read_b64_tr_b16 v[96:97], v18 offset:4096
    v_mfma_f32_16x16x32_bf16 v[44:47], v[100:103], v[132:135], v[44:47]
    ds_read_b64_tr_b16 v[98:99], v18 offset:4608
    s_waitcnt lgkmcnt(12)
    v_mfma_f32_16x16x32_bf16 v[48:51], v[104:107], v[128:131], v[48:51]
    ds_read_b64_tr_b16 v[100:101], v19 offset:4096
    v_mfma_f32_16x16x32_bf16 v[52:55], v[104:107], v[132:135], v[52:55]
    ds_read_b64_tr_b16 v[102:103], v19 offset:4608
    v_mfma_f32_16x16x32_bf16 v[56:59], v[108:111], v[128:131], v[56:59]
    ds_read_b64_tr_b16 v[104:105], v20 offset:4096
    v_mfma_f32_16x16x32_bf16 v[60:63], v[108:111], v[132:135], v[60:63]
    ds_read_b64_tr_b16 v[106:107], v20 offset:4608
    s_waitcnt lgkmcnt(12)
    v_mfma_f32_16x16x32_bf16 v[64:67], v[112:115], v[128:131], v[64:67]
    ds_read_b64_tr_b16 v[108:109], v21 offset:4096
    v_mfma_f32_16x16x32_bf16 v[68:71], v[112:115], v[132:135], v[68:71]
    ds_read_b64_tr_b16 v[110:111], v21 offset:4608
    v_mfma_f32_16x16x32_bf16 v[72:75], v[116:119], v[128:131], v[72:75]
    ds_read_b64_tr_b16 v[112:113], v18 offset:28672
    v_mfma_f32_16x16x32_bf16 v[76:79], v[116:119], v[132:135], v[76:79]
    ds_read_b64_tr_b16 v[114:115], v18 offset:29184
    s_waitcnt lgkmcnt(12)
    v_mfma_f32_16x16x32_bf16 v[80:83], v[120:123], v[128:131], v[80:83]
    ds_read_b64_tr_b16 v[116:117], v19 offset:28672
    v_mfma_f32_16x16x32_bf16 v[84:87], v[120:123], v[132:135], v[84:87]
    ds_read_b64_tr_b16 v[118:119], v19 offset:29184
    v_mfma_f32_16x16x32_bf16 v[88:91], v[124:127], v[128:131], v[88:91]
    ds_read_b64_tr_b16 v[120:121], v20 offset:28672
    v_mfma_f32_16x16x32_bf16 v[92:95], v[124:127], v[132:135], v[92:95]
    ds_read_b64_tr_b16 v[122:123], v20 offset:29184
    s_barrier
    s_waitcnt lgkmcnt(10)
    v_mfma_f32_16x16x32_bf16 v[32:35], v[96:99], v[136:139], v[32:35]
    ds_read_b64_tr_b16 v[124:125], v21 offset:28672
    v_mfma_f32_16x16x32_bf16 v[36:39], v[96:99], v[140:143], v[36:39]
    ds_read_b64_tr_b16 v[126:127], v21 offset:29184
    v_mfma_f32_16x16x32_bf16 v[40:43], v[100:103], v[136:139], v[40:43]
    v_mfma_f32_16x16x32_bf16 v[44:47], v[100:103], v[140:143], v[44:47]
    s_waitcnt lgkmcnt(8)
    v_mfma_f32_16x16x32_bf16 v[48:51], v[104:107], v[136:139], v[48:51]
    v_mfma_f32_16x16x32_bf16 v[52:55], v[104:107], v[140:143], v[52:55]
    v_mfma_f32_16x16x32_bf16 v[56:59], v[108:111], v[136:139], v[56:59]
    v_mfma_f32_16x16x32_bf16 v[60:63], v[108:111], v[140:143], v[60:63]
    s_waitcnt lgkmcnt(4)
    v_mfma_f32_16x16x32_bf16 v[64:67], v[112:115], v[136:139], v[64:67]
    v_mfma_f32_16x16x32_bf16 v[68:71], v[112:115], v[140:143], v[68:71]
    v_mfma_f32_16x16x32_bf16 v[72:75], v[116:119], v[136:139], v[72:75]
    v_mfma_f32_16x16x32_bf16 v[76:79], v[116:119], v[140:143], v[76:79]
    s_waitcnt lgkmcnt(0)
    v_mfma_f32_16x16x32_bf16 v[80:83], v[120:123], v[136:139], v[80:83]
    v_mfma_f32_16x16x32_bf16 v[84:87], v[120:123], v[140:143], v[84:87]
    v_mfma_f32_16x16x32_bf16 v[88:91], v[124:127], v[136:139], v[88:91]
    v_mfma_f32_16x16x32_bf16 v[92:95], v[124:127], v[140:143], v[92:95]
    s_barrier
    ds_read_b128 v[128:131], v16 offset:24576
    ds_read_b128 v[132:135], v16 offset:26624
    ds_read_b64_tr_b16 v[96:97], v18 offset:8192
    ds_read_b64_tr_b16 v[98:99], v18 offset:8704
    ds_read_b64_tr_b16 v[100:101], v19 offset:8192
    ds_read_b64_tr_b16 v[102:103], v19 offset:8704
    ds_read_b64_tr_b16 v[104:105], v20 offset:8192
    ds_read_b64_tr_b16 v[106:107], v20 offset:8704
    ds_read_b64_tr_b16 v[108:109], v21 offset:8192
    ds_read_b64_tr_b16 v[110:111], v21 offset:8704
    ds_read_b64_tr_b16 v[112:113], v18 offset:32768
    ds_read_b64_tr_b16 v[114:115], v18 offset:33280
    ds_read_b64_tr_b16 v[116:117], v19 offset:32768
    ds_read_b64_tr_b16 v[118:119], v19 offset:33280
    ds_read_b64_tr_b16 v[120:121], v20 offset:32768
    ds_read_b64_tr_b16 v[122:123], v20 offset:33280
    ds_read_b64_tr_b16 v[124:125], v21 offset:32768
    ds_read_b64_tr_b16 v[126:127], v21 offset:33280
L_cjoin:
    s_barrier
    s_waitcnt lgkmcnt(12)
    v_mfma_f32_16x16x32_bf16 v[32:35], v[96:99], v[128:131], v[32:35]
    ds_read_b128 v[136:139], v17 offset:24576
    v_mfma_f32_16x16x32_bf16 v[36:39], v[96:99], v[132:135], v[36:39]
    v_mfma_f32_16x16x32_bf16 v[40:43], v[100:103], v[128:131], v[40:43]
    ds_read_b128 v[140:143], v17 offset:26624
    ds_read_b64_tr_b16 v[96:97], v18 offset:12288
    v_mfma_f32_16x16x32_bf16 v[44:47], v[100:103], v[132:135], v[44:47]
    ds_read_b64_tr_b16 v[98:99], v18 offset:12800
    s_waitcnt lgkmcnt(12)
    v_mfma_f32_16x16x32_bf16 v[48:51], v[104:107], v[128:131], v[48:51]
    ds_read_b64_tr_b16 v[100:101], v19 offset:12288
    v_mfma_f32_16x16x32_bf16 v[52:55], v[104:107], v[132:135], v[52:55]
    ds_read_b64_tr_b16 v[102:103], v19 offset:12800
    v_mfma_f32_16x16x32_bf16 v[56:59], v[108:111], v[128:131], v[56:59]
    ds_read_b64_tr_b16 v[104:105], v20 offset:12288
    v_mfma_f32_16x16x32_bf16 v[60:63], v[108:111], v[132:135], v[60:63]
    ds_read_b64_tr_b16 v[106:107], v20 offset:12800
    s_waitcnt lgkmcnt(12)
    v_mfma_f32_16x16x32_bf16 v[64:67], v[112:115], v[128:131], v[64:67]
    ds_read_b64_tr_b16 v[108:109], v21 offset:12288
    v_mfma_f32_16x16x32_bf16 v[68:71], v[112:115], v[132:135], v[68:71]
    ds_read_b64_tr_b16 v[110:111], v21 offset:12800
    v_mfma_f32_16x16x32_bf16 v[72:75], v[116:119], v[128:131], v[72:75]
    ds_read_b64_tr_b16 v[112:113], v18 offset:36864
    v_mfma_f32_16x16x32_bf16 v[76:79], v[116:119], v[132:135], v[76:79]
    ds_read_b64_tr_b16 v[114:115], v18 offset:37376
    s_waitcnt lgkmcnt(12)
    v_mfma_f32_16x16x32_bf16 v[80:83], v[120:123], v[128:131], v[80:83]
    ds_read_b64_tr_b16 v[116:117], v19 offset:36864
    v_mfma_f32_16x16x32_bf16 v[84:87], v[120:123], v[132:135], v[84:87]
    ds_read_b64_tr_b16 v[118:119], v19 offset:37376
    v_mfma_f32_16x16x32_bf16 v[88:91], v[124:127], v[128:131], v[88:91]
    ds_read_b64_tr_b16 v[120:121], v20 offset:36864
    v_mfma_f32_16x16x32_bf16 v[92:95], v[124:127], v[132:135], v[92:95]
    ds_read_b64_tr_b16 v[122:123], v20 offset:37376
    s_barrier
    s_waitcnt lgkmcnt(10)
    v_mfma_f32_16x16x32_bf16 v[32:35], v[96:99], v[136:139], v[32:35]
    ds_read_b64_tr_b16 v[124:125], v21 offset:36864
    ds_read_b64_tr_b16 v[126:127], v21 offset:37376
    v_mfma_f32_16x16x32_bf16 v[36:39], v[96:99], v[140:143], v[36:39]
    ds_read_b128 v[128:131], v16 offset:32768
    v_mfma_f32_16x16x32_bf16 v[40:43], v[100:103], v[136:139], v[40:43]
    ds_read_b128 v[132:135], v16 offset:34816
    ds_read_b64_tr_b16 v[96:97], v18 offset:16384
    v_mfma_f32_16x16x32_bf16 v[44:47], v[100:103], v[140:143], v[44:47]
    ds_read_b64_tr_b16 v[98:99], v18 offset:16896
    s_waitcnt lgkmcnt(12)
    v_mfma_f32_16x16x32_bf16 v[48:51], v[104:107], v[136:139], v[48:51]
    ds_read_b64_tr_b16 v[100:101], v19 offset:16384
    v_mfma_f32_16x16x32_bf16 v[52:55], v[104:107], v[140:143], v[52:55]
    ds_read_b64_tr_b16 v[102:103], v19 offset:16896
    v_mfma_f32_16x16x32_bf16 v[56:59], v[108:111], v[136:139], v[56:59]
    ds_read_b64_tr_b16 v[104:105], v20 offset:16384
    v_mfma_f32_16x16x32_bf16 v[60:63], v[108:111], v[140:143], v[60:63]
    ds_read_b64_tr_b16 v[106:107], v20 offset:16896
    s_waitcnt lgkmcnt(12)
    v_mfma_f32_16x16x32_bf16 v[64:67], v[112:115], v[136:139], v[64:67]
    ds_read_b64_tr_b16 v[108:109], v21 offset:16384
    v_mfma_f32_16x16x32_bf16 v[68:71], v[112:115], v[140:143], v[68:71]
    ds_read_b64_tr_b16 v[110:111], v21 offset:16896
    v_mfma_f32_16x16x32_bf16 v[72:75], v[116:119], v[136:139], v[72:75]
    ds_read_b64_tr_b16 v[112:113], v18 offset:40960
    v_mfma_f32_16x16x32_bf16 v[76:79], v[116:119], v[140:143], v[76:79]
    ds_read_b64_tr_b16 v[114:115], v18 offset:41472
    s_waitcnt lgkmcnt(12)
    v_mfma_f32_16x16x32_bf16 v[80:83], v[120:123], v[136:139], v[80:83]
    ds_read_b64_tr_b16 v[116:117], v19 offset:40960
    v_mfma_f32_16x16x32_bf16 v[84:87], v[120:123], v[140:143], v[84:87]
    ds_read_b64_tr_b16 v[118:119], v19 offset:41472
    v_mfma_f32_16x16x32_bf16 v[88:91], v[124:127], v[136:139], v[88:91]
    ds_read_b64_tr_b16 v[120:121], v20 offset:40960
    v_mfma_f32_16x16x32_bf16 v[92:95], v[124:127], v[140:143], v[92:95]
    ds_read_b64_tr_b16 v[122:123], v20 offset:41472
    s_barrier
    s_waitcnt lgkmcnt(10)
    v_mfma_f32_16x16x32_bf16 v[32:35], v[96:99], v[128:131], v[32:35]
    ds_read_b64_tr_b16 v[124:125], v21 offset:40960
    v_mfma_f32_16x16x32_bf16 v[36:39], v[96:99], v[132:135], v[36:39]
    ds_read_b64_tr_b16 v[126:127], v21 offset:41472
    v_mfma_f32_16x16x32_bf16 v[40:43], v[100:103], v[128:131], v[40:43]
    v_mfma_f32_16x16x32_bf16 v[44:47], v[100:103], v[132:135], v[44:47]
    s_waitcnt lgkmcnt(8)
    v_mfma_f32_16x16x32_bf16 v[48:51], v[104:107], v[128:131], v[48:51]
    v_mfma_f32_16x16x32_bf16 v[52:55], v[104:107], v[132:135], v[52:55]
    v_mfma_f32_16x16x32_bf16 v[56:59], v[108:111], v[128:131], v[56:59]
    v_mfma_f32_16x16x32_bf16 v[60:63], v[108:111], v[132:135], v[60:63]
    s_waitcnt lgkmcnt(4)
    v_mfma_f32_16x16x32_bf16 v[64:67], v[112:115], v[128:131], v[64:67]
    v_mfma_f32_16x16x32_bf16 v[68:71], v[112:115], v[132:135], v[68:71]
    v_mfma_f32_16x16x32_bf16 v[72:75], v[116:119], v[128:131], v[72:75]
    v_mfma_f32_16x16x32_bf16 v[76:79], v[116:119], v[132:135], v[76:79]
    s_waitcnt lgkmcnt(0)
    v_mfma_f32_16x16x32_bf16 v[80:83], v[120:123], v[128:131], v[80:83]
    v_mfma_f32_16x16x32_bf16 v[84:87], v[120:123], v[132:135], v[84:87]
    v_mfma_f32_16x16x32_bf16 v[88:91], v[124:127], v[128:131], v[88:91]
    v_mfma_f32_16x16x32_bf16 v[92:95], v[124:127], v[132:135], v[92:95]
    s_barrier
    ds_read_b128 v[136:139], v17 offset:32768
    ds_read_b128 v[140:143], v17 offset:34816
    ds_read_b64_tr_b16 v[96:97], v18 offset:20480
    ds_read_b64_tr_b16 v[98:99], v18 offset:20992
    ds_read_b64_tr_b16 v[100:101], v19 offset:20480
    ds_read_b64_tr_b16 v[102:103], v19 offset:20992
    ds_read_b64_tr_b16 v[104:105], v20 offset:20480
    ds_read_b64_tr_b16 v[106:107], v20 offset:20992
    ds_read_b64_tr_b16 v[108:109], v21 offset:20480
    ds_read_b64_tr_b16 v[110:111], v21 offset:20992
    ds_read_b64_tr_b16 v[112:113], v18 offset:45056
    ds_read_b64_tr_b16 v[114:115], v18 offset:45568
    ds_read_b64_tr_b16 v[116:117], v19 offset:45056
    ds_read_b64_tr_b16 v[118:119], v19 offset:45568
    ds_read_b64_tr_b16 v[120:121], v20 offset:45056
    ds_read_b64_tr_b16 v[122:123], v20 offset:45568
    ds_read_b64_tr_b16 v[124:125], v21 offset:45056
    ds_read_b64_tr_b16 v[126:127], v21 offset:45568
    buffer_load_dwordx4 v[26:29], v10, s[24:27], 0 offen sc1
    s_barrier
    s_waitcnt lgkmcnt(12)
    v_mfma_f32_16x16x32_bf16 v[32:35], v[96:99], v[136:139], v[32:35]
    ds_read_b128 v[128:131], v16 offset:40960
    v_mfma_f32_16x16x32_bf16 v[36:39], v[96:99], v[140:143], v[36:39]
    v_mfma_f32_16x16x32_bf16 v[40:43], v[100:103], v[136:139], v[40:43]
    ds_read_b128 v[132:135], v16 offset:43008
    ds_read_b64_tr_b16 v[96:97], v18 offset:0
    v_mfma_f32_16x16x32_bf16 v[44:47], v[100:103], v[140:143], v[44:47]
    ds_read_b64_tr_b16 v[98:99], v18 offset:512
    s_waitcnt lgkmcnt(12)
    v_mfma_f32_16x16x32_bf16 v[48:51], v[104:107], v[136:139], v[48:51]
    ds_read_b64_tr_b16 v[100:101], v19 offset:0
    v_mfma_f32_16x16x32_bf16 v[52:55], v[104:107], v[140:143], v[52:55]
    ds_read_b64_tr_b16 v[102:103], v19 offset:512
    v_mfma_f32_16x16x32_bf16 v[56:59], v[108:111], v[136:139], v[56:59]
    ds_read_b64_tr_b16 v[104:105], v20 offset:0
    v_mfma_f32_16x16x32_bf16 v[60:63], v[108:111], v[140:143], v[60:63]
    ds_read_b64_tr_b16 v[106:107], v20 offset:512
    s_waitcnt lgkmcnt(12)
    v_mfma_f32_16x16x32_bf16 v[64:67], v[112:115], v[136:139], v[64:67]
    ds_read_b64_tr_b16 v[108:109], v21 offset:0
    v_mfma_f32_16x16x32_bf16 v[68:71], v[112:115], v[140:143], v[68:71]
    ds_read_b64_tr_b16 v[110:111], v21 offset:512
    v_mfma_f32_16x16x32_bf16 v[72:75], v[116:119], v[136:139], v[72:75]
    ds_read_b64_tr_b16 v[112:113], v18 offset:24576
    v_mfma_f32_16x16x32_bf16 v[76:79], v[116:119], v[140:143], v[76:79]
    ds_read_b64_tr_b16 v[114:115], v18 offset:25088
    s_waitcnt lgkmcnt(12)
    v_mfma_f32_16x16x32_bf16 v[80:83], v[120:123], v[136:139], v[80:83]
    ds_read_b64_tr_b16 v[116:117], v19 offset:24576
    v_mfma_f32_16x16x32_bf16 v[84:87], v[120:123], v[140:143], v[84:87]
    ds_read_b64_tr_b16 v[118:119], v19 offset:25088
    v_mfma_f32_16x16x32_bf16 v[88:91], v[124:127], v[136:139], v[88:91]
    ds_read_b64_tr_b16 v[120:121], v20 offset:24576
    v_mfma_f32_16x16x32_bf16 v[92:95], v[124:127], v[140:143], v[92:95]
    ds_read_b64_tr_b16 v[122:123], v20 offset:25088
    s_barrier
    s_waitcnt lgkmcnt(10)
    v_mfma_f32_16x16x32_bf16 v[32:35], v[96:99], v[128:131], v[32:35]
    ds_read_b64_tr_b16 v[124:125], v21 offset:24576
    ds_read_b64_tr_b16 v[126:127], v21 offset:25088
    v_mfma_f32_16x16x32_bf16 v[36:39], v[96:99], v[132:135], v[36:39]
    ds_read_b128 v[136:139], v17 offset:40960
    v_mfma_f32_16x16x32_bf16 v[40:43], v[100:103], v[128:131], v[40:43]
    ds_read_b128 v[140:143], v17 offset:43008
    ds_read_b64_tr_b16 v[96:97], v18 offset:4096
    v_mfma_f32_16x16x32_bf16 v[44:47], v[100:103], v[132:135], v[44:47]
    ds_read_b64_tr_b16 v[98:99], v18 offset:4608
    s_waitcnt lgkmcnt(12)
    v_mfma_f32_16x16x32_bf16 v[48:51], v[104:107], v[128:131], v[48:51]
    ds_read_b64_tr_b16 v[100:101], v19 offset:4096
    v_mfma_f32_16x16x32_bf16 v[52:55], v[104:107], v[132:135], v[52:55]
    ds_read_b64_tr_b16 v[102:103], v19 offset:4608
    v_mfma_f32_16x16x32_bf16 v[56:59], v[108:111], v[128:131], v[56:59]
    ds_read_b64_tr_b16 v[104:105], v20 offset:4096
    v_mfma_f32_16x16x32_bf16 v[60:63], v[108:111], v[132:135], v[60:63]
    ds_read_b64_tr_b16 v[106:107], v20 offset:4608
    s_waitcnt lgkmcnt(12)
    v_mfma_f32_16x16x32_bf16 v[64:67], v[112:115], v[128:131], v[64:67]
    ds_read_b64_tr_b16 v[108:109], v21 offset:4096
    v_mfma_f32_16x16x32_bf16 v[68:71], v[112:115], v[132:135], v[68:71]
    ds_read_b64_tr_b16 v[110:111], v21 offset:4608
    v_mfma_f32_16x16x32_bf16 v[72:75], v[116:119], v[128:131], v[72:75]
    ds_read_b64_tr_b16 v[112:113], v18 offset:28672
    v_mfma_f32_16x16x32_bf16 v[76:79], v[116:119], v[132:135], v[76:79]
    ds_read_b64_tr_b16 v[114:115], v18 offset:29184
    s_waitcnt lgkmcnt(12)
    v_mfma_f32_16x16x32_bf16 v[80:83], v[120:123], v[128:131], v[80:83]
    ds_read_b64_tr_b16 v[116:117], v19 offset:28672
    v_mfma_f32_16x16x32_bf16 v[84:87], v[120:123], v[132:135], v[84:87]
    ds_read_b64_tr_b16 v[118:119], v19 offset:29184
    v_mfma_f32_16x16x32_bf16 v[88:91], v[124:127], v[128:131], v[88:91]
    ds_read_b64_tr_b16 v[120:121], v20 offset:28672
    v_mfma_f32_16x16x32_bf16 v[92:95], v[124:127], v[132:135], v[92:95]
    ds_read_b64_tr_b16 v[122:123], v20 offset:29184
    s_barrier
    s_waitcnt lgkmcnt(10)
    v_mfma_f32_16x16x32_bf16 v[32:35], v[96:99], v[136:139], v[32:35]
    ds_read_b64_tr_b16 v[124:125], v21 offset:28672
    ds_read_b64_tr_b16 v[126:127], v21 offset:29184
    v_mfma_f32_16x16x32_bf16 v[36:39], v[96:99], v[140:143], v[36:39]
    ds_read_b128 v[128:131], v16 offset:49152
    s_waitcnt vmcnt(0)
    v_mfma_f32_16x16x32_bf16 v[40:43], v[100:103], v[136:139], v[40:43]
    ds_read_b128 v[132:135], v16 offset:51200
    ds_read_b64_tr_b16 v[96:97], v18 offset:8192
    v_mfma_f32_16x16x32_bf16 v[44:47], v[100:103], v[140:143], v[44:47]
    ds_read_b64_tr_b16 v[98:99], v18 offset:8704
    v_and_b32 v1, 0x100, v26
    s_waitcnt lgkmcnt(12)
    v_mfma_f32_16x16x32_bf16 v[48:51], v[104:107], v[136:139], v[48:51]
    ds_read_b64_tr_b16 v[100:101], v19 offset:8192
    v_mfma_f32_16x16x32_bf16 v[52:55], v[104:107], v[140:143], v[52:55]
    ds_read_b64_tr_b16 v[102:103], v19 offset:8704
    v_cmp_eq_u32 vcc, 0, v1
    s_nop 1
    v_mfma_f32_16x16x32_bf16 v[56:59], v[108:111], v[136:139], v[56:59]
    ds_read_b64_tr_b16 v[104:105], v20 offset:8192
    v_mfma_f32_16x16x32_bf16 v[60:63], v[108:111], v[140:143], v[60:63]
    ds_read_b64_tr_b16 v[106:107], v20 offset:8704
    s_cbranch_vccnz L_n0_slow
L_n0_ok:
    v_readfirstlane_b32 s65, v26
    s_waitcnt lgkmcnt(12)
    v_mfma_f32_16x16x32_bf16 v[64:67], v[112:115], v[136:139], v[64:67]
    ds_read_b64_tr_b16 v[108:109], v21 offset:8192
    v_mfma_f32_16x16x32_bf16 v[68:71], v[112:115], v[140:143], v[68:71]
    ds_read_b64_tr_b16 v[110:111], v21 offset:8704
    v_readfirstlane_b32 s66, v28
    s_nop 0
    v_mfma_f32_16x16x32_bf16 v[72:75], v[116:119], v[136:139], v[72:75]
    ds_read_b64_tr_b16 v[112:113], v18 offset:32768
    v_mfma_f32_16x16x32_bf16 v[76:79], v[116:119], v[140:143], v[76:79]
    ds_read_b64_tr_b16 v[114:115], v18 offset:33280
    s_and_b32 s64, s65, 0xff
    s_and_b32 s65, s65, 0xc000c000
    s_waitcnt lgkmcnt(12)
    v_mfma_f32_16x16x32_bf16 v[80:83], v[120:123], v[136:139], v[80:83]
    ds_read_b64_tr_b16 v[116:117], v19 offset:32768
    v_mfma_f32_16x16x32_bf16 v[84:87], v[120:123], v[140:143], v[84:87]
    ds_read_b64_tr_b16 v[118:119], v19 offset:33280
    s_and_b32 s66, s66, 0xc000c000
    v_mul_u32_u24 v6, 0x2ddc6b, v3
    v_mfma_f32_16x16x32_bf16 v[88:91], v[124:127], v[136:139], v[88:91]
    ds_read_b64_tr_b16 v[120:121], v20 offset:32768
    v_mfma_f32_16x16x32_bf16 v[92:95], v[124:127], v[140:143], v[92:95]
    ds_read_b64_tr_b16 v[122:123], v20 offset:33280
    v_mul_u32_u24 v7, 0x7cd6e9, v3
    v_and_b32 v6, 0xc000c000, v6
    v_and_b32 v7, 0xc000c000, v7
    v_xor_b32 v6, s65, v6
    v_xor_b32 v7, s66, v7
    s_barrier
    s_waitcnt lgkmcnt(10)
    v_mfma_f32_16x16x32_bf16 v[32:35], v[96:99], v[128:131], v[32:35]
    ds_read_b64_tr_b16 v[124:125], v21 offset:32768
    v_mfma_f32_16x16x32_bf16 v[36:39], v[96:99], v[132:135], v[36:39]
    ds_read_b64_tr_b16 v[126:127], v21 offset:33280
    v_mfma_f32_16x16x32_bf16 v[40:43], v[100:103], v[128:131], v[40:43]
    ds_read_b64_tr_b16 v[224:225], v12 offset:12288
    v_mfma_f32_16x16x32_bf16 v[44:47], v[100:103], v[132:135], v[44:47]
    ds_read_b64_tr_b16 v[226:227], v12 offset:12800
    s_waitcnt lgkmcnt(10)
    v_mfma_f32_16x16x32_bf16 v[48:51], v[104:107], v[128:131], v[48:51]
    ds_read_b64_tr_b16 v[228:229], v13 offset:12288
    v_mfma_f32_16x16x32_bf16 v[52:55], v[104:107], v[132:135], v[52:55]
    ds_read_b64_tr_b16 v[230:231], v13 offset:12800
    v_mfma_f32_16x16x32_bf16 v[56:59], v[108:111], v[128:131], v[56:59]
    ds_read_b64_tr_b16 v[232:233], v12 offset:36864
    v_mfma_f32_16x16x32_bf16 v[60:63], v[108:111], v[132:135], v[60:63]
    ds_read_b64_tr_b16 v[234:235], v12 offset:37376
    s_waitcnt lgkmcnt(10)
    v_mfma_f32_16x16x32_bf16 v[64:67], v[112:115], v[128:131], v[64:67]
    ds_read_b64_tr_b16 v[236:237], v13 offset:36864
    v_mfma_f32_16x16x32_bf16 v[68:71], v[112:115], v[132:135], v[68:71]
    ds_read_b64_tr_b16 v[238:239], v13 offset:37376
    v_mfma_f32_16x16x32_bf16 v[72:75], v[116:119], v[128:131], v[72:75]
    v_mfma_f32_16x16x32_bf16 v[76:79], v[116:119], v[132:135], v[76:79]
    s_waitcnt lgkmcnt(8)
    v_mfma_f32_16x16x32_bf16 v[80:83], v[120:123], v[128:131], v[80:83]
    v_mfma_f32_16x16x32_bf16 v[84:87], v[120:123], v[132:135], v[84:87]
    v_mfma_f32_16x16x32_bf16 v[88:91], v[124:127], v[128:131], v[88:91]
    v_mfma_f32_16x16x32_bf16 v[92:95], v[124:127], v[132:135], v[92:95]
    s_barrier
    ds_read_b128 v[136:139], v17 offset:49152
    ds_read_b128 v[140:143], v17 offset:51200
    ds_read_b64_tr_b16 v[96:97], v18 offset:16384
    ds_read_b64_tr_b16 v[98:99], v18 offset:16896
    ds_read_b64_tr_b16 v[100:101], v19 offset:16384
    ds_read_b64_tr_b16 v[102:103], v19 offset:16896
    ds_read_b64_tr_b16 v[104:105], v20 offset:16384
    ds_read_b64_tr_b16 v[106:107], v20 offset:16896
    ds_read_b64_tr_b16 v[108:109], v21 offset:16384
    ds_read_b64_tr_b16 v[110:111], v21 offset:16896
    ds_read_b64_tr_b16 v[112:113], v18 offset:40960
    ds_read_b64_tr_b16 v[114:115], v18 offset:41472
    ds_read_b64_tr_b16 v[116:117], v19 offset:40960
    ds_read_b64_tr_b16 v[118:119], v19 offset:41472
    ds_read_b64_tr_b16 v[120:121], v20 offset:40960
    ds_read_b64_tr_b16 v[122:123], v20 offset:41472
    ds_read_b64_tr_b16 v[124:125], v21 offset:40960
    ds_read_b64_tr_b16 v[126:127], v21 offset:41472
    s_waitcnt lgkmcnt(12)
    v_mfma_f32_16x16x32_bf16 v[32:35], v[96:99], v[136:139], v[32:35]
    v_mfma_f32_16x16x32_bf16 v[36:39], v[96:99], v[140:143], v[36:39]
    v_mfma_f32_16x16x32_bf16 v[40:43], v[100:103], v[136:139], v[40:43]
    v_mfma_f32_16x16x32_bf16 v[44:47], v[100:103], v[140:143], v[44:47]
    s_waitcnt lgkmcnt(8)
    v_mfma_f32_16x16x32_bf16 v[48:51], v[104:107], v[136:139], v[48:51]
    v_mfma_f32_16x16x32_bf16 v[52:55], v[104:107], v[140:143], v[52:55]
    v_mfma_f32_16x16x32_bf16 v[56:59], v[108:111], v[136:139], v[56:59]
    s_nop 0
    v_cvt_pk_bf16_f32 v32, v32, v33
    v_mfma_f32_16x16x32_bf16 v[60:63], v[108:111], v[140:143], v[60:63]
    v_cvt_pk_bf16_f32 v33, v34, v35
    s_waitcnt lgkmcnt(4)
    v_mfma_f32_16x16x32_bf16 v[64:67], v[112:115], v[136:139], v[64:67]
    v_cvt_pk_bf16_f32 v34, v36, v37
    v_cvt_pk_bf16_f32 v35, v38, v39
    v_mfma_f32_16x16x32_bf16 v[68:71], v[112:115], v[140:143], v[68:71]
    v_cvt_pk_bf16_f32 v36, v40, v41
    v_mfma_f32_16x16x32_bf16 v[72:75], v[116:119], v[136:139], v[72:75]
    v_cvt_pk_bf16_f32 v37, v42, v43
    v_cvt_pk_bf16_f32 v38, v44, v45
    v_mfma_f32_16x16x32_bf16 v[76:79], v[116:119], v[140:143], v[76:79]
    v_cvt_pk_bf16_f32 v39, v46, v47
    s_waitcnt lgkmcnt(0)
    v_mfma_f32_16x16x32_bf16 v[80:83], v[120:123], v[136:139], v[80:83]
    v_permlane16_swap_b32 v32, v34
    v_permlane16_swap_b32 v33, v35
    v_mfma_f32_16x16x32_bf16 v[84:87], v[120:123], v[140:143], v[84:87]
    v_cvt_pk_bf16_f32 v40, v48, v49
    v_mfma_f32_16x16x32_bf16 v[88:91], v[124:127], v[136:139], v[88:91]
    v_cvt_pk_bf16_f32 v41, v50, v51
    v_cvt_pk_bf16_f32 v42, v52, v53
    v_mfma_f32_16x16x32_bf16 v[92:95], v[124:127], v[140:143], v[92:95]
    v_cvt_pk_bf16_f32 v43, v54, v55
    v_mfma_f32_32x32x16_bf16 v[144:159], v[160:163], v[32:35], 0
    v_permlane16_swap_b32 v36, v38
    v_permlane16_swap_b32 v37, v39
    v_cvt_pk_bf16_f32 v44, v56, v57
    v_cvt_pk_bf16_f32 v45, v58, v59
    v_cvt_pk_bf16_f32 v46, v60, v61
    v_cvt_pk_bf16_f32 v47, v62, v63
    v_mfma_f32_32x32x16_bf16 v[144:159], v[164:167], v[36:39], v[144:159]
    v_permlane16_swap_b32 v40, v42
    v_permlane16_swap_b32 v41, v43
    v_cvt_pk_bf16_f32 v48, v64, v65
    v_cvt_pk_bf16_f32 v49, v66, v67
    v_cvt_pk_bf16_f32 v50, v68, v69
    v_cvt_pk_bf16_f32 v51, v70, v71
    v_mfma_f32_32x32x16_bf16 v[144:159], v[168:171], v[40:43], v[144:159]
    v_permlane16_swap_b32 v44, v46
    v_permlane16_swap_b32 v45, v47
    v_cvt_pk_bf16_f32 v52, v72, v73
    v_cvt_pk_bf16_f32 v53, v74, v75
    v_cvt_pk_bf16_f32 v54, v76, v77
    v_cvt_pk_bf16_f32 v55, v78, v79
    v_mfma_f32_32x32x16_bf16 v[144:159], v[172:175], v[44:47], v[144:159]
    v_permlane16_swap_b32 v48, v50
    v_permlane16_swap_b32 v49, v51
    v_cvt_pk_bf16_f32 v56, v80, v81
    v_cvt_pk_bf16_f32 v57, v82, v83
    v_cvt_pk_bf16_f32 v58, v84, v85
    v_cvt_pk_bf16_f32 v59, v86, v87
    v_mfma_f32_32x32x16_bf16 v[144:159], v[176:179], v[48:51], v[144:159]
    v_permlane16_swap_b32 v52, v54
    v_permlane16_swap_b32 v53, v55
    v_cvt_pk_bf16_f32 v60, v88, v89
    v_cvt_pk_bf16_f32 v61, v90, v91
    v_cvt_pk_bf16_f32 v62, v92, v93
    v_cvt_pk_bf16_f32 v63, v94, v95
    v_mfma_f32_32x32x16_bf16 v[144:159], v[180:183], v[52:55], v[144:159]
    v_permlane16_swap_b32 v56, v58
    v_permlane16_swap_b32 v57, v59
    v_permlane16_swap_b32 v60, v62
    v_permlane16_swap_b32 v61, v63
    v_mfma_f32_32x32x16_bf16 v[144:159], v[184:187], v[56:59], v[144:159]
    s_nop 0
    v_mfma_f32_32x32x16_bf16 v[144:159], v[188:191], v[60:63], v[144:159]
    s_cmp_lt_u32 s49, 2
    s_cbranch_scc1 L_nos0
    s_nop 9
    ds_write_b128 v9, v[144:147] offset:0
    ds_write_b128 v9, v[148:151] offset:1024
    ds_write_b128 v9, v[152:155] offset:2048
    ds_write_b128 v9, v[156:159] offset:3072
L_nos0:
    s_waitcnt lgkmcnt(0)
    s_barrier
    s_cmp_eq_u32 s98, 7
    s_cbranch_scc1 L_spare0
    ds_read_b128 v[80:83], v9 offset:0
    ds_read_b128 v[84:87], v9 offset:1024
    ds_read_b128 v[88:91], v9 offset:2048
    ds_read_b128 v[92:95], v9 offset:3072
    s_waitcnt lgkmcnt(3)
    v_pk_add_f32 v[144:145], v[144:145], v[80:81]
    v_pk_add_f32 v[146:147], v[146:147], v[82:83]
    s_waitcnt lgkmcnt(2)
    v_pk_add_f32 v[148:149], v[148:149], v[84:85]
    v_pk_add_f32 v[150:151], v[150:151], v[86:87]
    s_waitcnt lgkmcnt(1)
    v_pk_add_f32 v[152:153], v[152:153], v[88:89]
    v_pk_add_f32 v[154:155], v[154:155], v[90:91]
    s_waitcnt lgkmcnt(0)
    v_pk_add_f32 v[156:157], v[156:157], v[92:93]
    v_pk_add_f32 v[158:159], v[158:159], v[94:95]
    v_max3_f32 v80, v144, v145, v146
    v_max3_f32 v81, v147, v148, v149
    v_max3_f32 v80, v80, v150, v151
    v_max3_f32 v81, v81, v152, v153
    v_max3_f32 v80, v80, v154, v155
    v_max3_f32 v81, v81, v156, v157
    v_max3_f32 v80, v80, v158, v159
    v_max_f32 v80, v80, v81
    v_mov_b32 v81, v80
    s_nop 1
    v_permlane32_swap_b32 v80, v81
    s_nop 1
    v_max_f32 v80, v80, v81
    v_mul_f32 v80, s62, v80
    v_pk_fma_f32 v[144:145], v[144:145], s[62:63], v[80:81] op_sel_hi:[1,0,0] neg_lo:[0,0,1] neg_hi:[0,0,1]
    v_pk_fma_f32 v[146:147], v[146:147], s[62:63], v[80:81] op_sel_hi:[1,0,0] neg_lo:[0,0,1] neg_hi:[0,0,1]
    v_pk_fma_f32 v[148:149], v[148:149], s[62:63], v[80:81] op_sel_hi:[1,0,0] neg_lo:[0,0,1] neg_hi:[0,0,1]
    v_pk_fma_f32 v[150:151], v[150:151], s[62:63], v[80:81] op_sel_hi:[1,0,0] neg_lo:[0,0,1] neg_hi:[0,0,1]
    v_pk_fma_f32 v[152:153], v[152:153], s[62:63], v[80:81] op_sel_hi:[1,0,0] neg_lo:[0,0,1] neg_hi:[0,0,1]
    v_pk_fma_f32 v[154:155], v[154:155], s[62:63], v[80:81] op_sel_hi:[1,0,0] neg_lo:[0,0,1] neg_hi:[0,0,1]
    v_pk_fma_f32 v[156:157], v[156:157], s[62:63], v[80:81] op_sel_hi:[1,0,0] neg_lo:[0,0,1] neg_hi:[0,0,1]
    v_pk_fma_f32 v[158:159], v[158:159], s[62:63], v[80:81] op_sel_hi:[1,0,0] neg_lo:[0,0,1] neg_hi:[0,0,1]
    v_exp_f32 v144, v144
    v_exp_f32 v145, v145
    v_exp_f32 v146, v146
    v_exp_f32 v147, v147
    v_exp_f32 v148, v148
    v_exp_f32 v149, v149
    v_exp_f32 v150, v150
    v_exp_f32 v151, v151
    v_exp_f32 v152, v152
    v_exp_f32 v153, v153
    v_exp_f32 v154, v154
    v_exp_f32 v155, v155
    v_exp_f32 v156, v156
    v_exp_f32 v157, v157
    v_exp_f32 v158, v158
    v_exp_f32 v159, v159
    s_nop 0
    v_pk_add_f32 v[82:83], v[144:145], v[152:153]
    v_pk_add_f32 v[84:85], v[146:147], v[154:155]
    v_pk_add_f32 v[86:87], v[148:149], v[156:157]
    v_pk_add_f32 v[88:89], v[150:151], v[158:159]
    v_pk_add_f32 v[82:83], v[82:83], v[86:87]
    v_pk_add_f32 v[84:85], v[84:85], v[88:89]
    v_pk_add_f32 v[82:83], v[82:83], v[84:85]
    v_add_f32 v80, v82, v83
    v_mov_b32 v81, v80
    s_nop 1
    v_permlane32_swap_b32 v80, v81
    s_nop 1
    v_add_f32 v80, v80, v81
    v_rcp_f32 v80, v80
    s_nop 0
    v_pk_mul_f32 v[144:145], v[144:145], v[80:81] op_sel_hi:[1,0]
    v_pk_mul_f32 v[146:147], v[146:147], v[80:81] op_sel_hi:[1,0]
    v_pk_mul_f32 v[148:149], v[148:149], v[80:81] op_sel_hi:[1,0]
    v_pk_mul_f32 v[150:151], v[150:151], v[80:81] op_sel_hi:[1,0]
    v_pk_mul_f32 v[152:153], v[152:153], v[80:81] op_sel_hi:[1,0]
    v_pk_mul_f32 v[154:155], v[154:155], v[80:81] op_sel_hi:[1,0]
    v_pk_mul_f32 v[156:157], v[156:157], v[80:81] op_sel_hi:[1,0]
    v_pk_mul_f32 v[158:159], v[158:159], v[80:81] op_sel_hi:[1,0]
    v_cvt_pk_bf16_f32 v84, v144, v145
    v_cvt_pk_bf16_f32 v85, v146, v147
    v_cvt_pk_bf16_f32 v86, v148, v149
    v_cvt_pk_bf16_f32 v87, v150, v151
    v_cvt_pk_bf16_f32 v88, v152, v153
    v_cvt_pk_bf16_f32 v89, v154, v155
    v_cvt_pk_bf16_f32 v90, v156, v157
    v_cvt_pk_bf16_f32 v91, v158, v159
    v_and_or_b32 v84, v84, s61, v6
    v_and_or_b32 v86, v86, s61, v7
    v_and_or_b32 v88, v88, s61, v6
    v_and_or_b32 v90, v90, s61, v7
    s_cmp_ge_u32 s49, 2
    s_cbranch_scc1 L_t0st
    buffer_store_dwordx4 v[84:87], v3, s[40:43], s69 offen sc1
    buffer_store_dwordx4 v[88:91], v3, s[40:43], s69 offen offset:1024 sc1
L_t0st:
    s_barrier
    ds_read_b128 v[192:195], v4 offset:20480
    ds_read_b128 v[196:199], v4 offset:22528
    ds_read_b128 v[200:203], v4 offset:45056
    ds_read_b128 v[204:207], v4 offset:47104
    ds_read_b128 v[208:211], v5 offset:20480
    ds_read_b128 v[212:215], v5 offset:22528
    ds_read_b128 v[216:219], v5 offset:45056
    ds_read_b128 v[220:223], v5 offset:47104
    s_barrier
    ds_read_b64_tr_b16 v[240:241], v12 offset:0
    ds_read_b64_tr_b16 v[242:243], v12 offset:512
    ds_read_b64_tr_b16 v[244:245], v13 offset:0
    ds_read_b64_tr_b16 v[246:247], v13 offset:512
    ds_read_b64_tr_b16 v[248:249], v12 offset:24576
    ds_read_b64_tr_b16 v[250:251], v12 offset:25088
    ds_read_b64_tr_b16 v[252:253], v13 offset:24576
    ds_read_b64_tr_b16 v[254:255], v13 offset:25088
    s_waitcnt lgkmcnt(8)
    s_barrier
    ds_read_b64_tr_b16 v[96:97], v12 offset:4096
    ds_read_b64_tr_b16 v[98:99], v12 offset:4608
    ds_read_b64_tr_b16 v[100:101], v13 offset:4096
    ds_read_b64_tr_b16 v[102:103], v13 offset:4608
    ds_read_b64_tr_b16 v[104:105], v12 offset:28672
    ds_read_b64_tr_b16 v[106:107], v12 offset:29184
    ds_read_b64_tr_b16 v[108:109], v13 offset:28672
    ds_read_b64_tr_b16 v[110:111], v13 offset:29184
    s_waitcnt lgkmcnt(8)
    s_barrier
L_slot0:
    v_mfma_f32_16x16x32_bf16 v[32:35], v[192:195], v[224:227], 0
    v_mfma_f32_16x16x32_bf16 v[36:39], v[192:195], v[228:231], 0
    v_mfma_f32_16x16x32_bf16 v[40:43], v[196:199], v[224:227], 0
    ds_read_b128 v[192:195], v4 offset:8192
    v_mfma_f32_16x16x32_bf16 v[44:47], v[196:199], v[228:231], 0
    v_mfma_f32_16x16x32_bf16 v[48:51], v[200:203], v[232:235], 0
    ds_read_b128 v[196:199], v4 offset:10240
    v_mfma_f32_16x16x32_bf16 v[52:55], v[200:203], v[236:239], 0
    v_mfma_f32_16x16x32_bf16 v[56:59], v[204:207], v[232:235], 0
    ds_read_b128 v[200:203], v4 offset:32768
    v_mfma_f32_16x16x32_bf16 v[60:63], v[204:207], v[236:239], 0
    v_mfma_f32_16x16x32_bf16 v[32:35], v[208:211], v[240:243], v[32:35]
    ds_read_b128 v[204:207], v4 offset:34816
    v_mfma_f32_16x16x32_bf16 v[36:39], v[208:211], v[244:247], v[36:39]
    v_mfma_f32_16x16x32_bf16 v[40:43], v[212:215], v[240:243], v[40:43]
    ds_read_b128 v[208:211], v5 offset:8192
    v_mfma_f32_16x16x32_bf16 v[44:47], v[212:215], v[244:247], v[44:47]
    v_mfma_f32_16x16x32_bf16 v[48:51], v[216:219], v[248:251], v[48:51]
    ds_read_b128 v[212:215], v5 offset:10240
    v_mfma_f32_16x16x32_bf16 v[52:55], v[216:219], v[252:255], v[52:55]
    v_mfma_f32_16x16x32_bf16 v[56:59], v[220:223], v[248:251], v[56:59]
    ds_read_b128 v[216:219], v5 offset:32768
    v_mfma_f32_16x16x32_bf16 v[60:63], v[220:223], v[252:255], v[60:63]
    s_waitcnt lgkmcnt(7)
    s_barrier
    ds_read_b128 v[220:223], v5 offset:34816
    ds_read_b64_tr_b16 v[112:113], v12 offset:12288
    ds_read_b64_tr_b16 v[114:115], v12 offset:12800
    ds_read_b64_tr_b16 v[116:117], v13 offset:12288
    ds_read_b64_tr_b16 v[118:119], v13 offset:12800
    ds_read_b64_tr_b16 v[120:121], v12 offset:36864
    ds_read_b64_tr_b16 v[122:123], v12 offset:37376
    ds_read_b64_tr_b16 v[124:125], v13 offset:36864
    ds_read_b64_tr_b16 v[126:127], v13 offset:37376
    s_waitcnt lgkmcnt(8)
    s_barrier
L_slot1:
    v_mfma_f32_16x16x32_bf16 v[32:35], v[192:195], v[96:99], v[32:35]
    v_mfma_f32_16x16x32_bf16 v[36:39], v[192:195], v[100:103], v[36:39]
    v_mfma_f32_16x16x32_bf16 v[40:43], v[196:199], v[96:99], v[40:43]
    ds_read_b128 v[192:195], v4 offset:16384
    v_mfma_f32_16x16x32_bf16 v[44:47], v[196:199], v[100:103], v[44:47]
    v_mfma_f32_16x16x32_bf16 v[48:51], v[200:203], v[104:107], v[48:51]
    ds_read_b128 v[196:199], v4 offset:18432
    v_mfma_f32_16x16x32_bf16 v[52:55], v[200:203], v[108:111], v[52:55]
    v_mfma_f32_16x16x32_bf16 v[56:59], v[204:207], v[104:107], v[56:59]
    ds_read_b128 v[200:203], v4 offset:40960
    v_mfma_f32_16x16x32_bf16 v[60:63], v[204:207], v[108:111], v[60:63]
    s_waitcnt lgkmcnt(3)
    v_mfma_f32_16x16x32_bf16 v[32:35], v[208:211], v[112:115], v[32:35]
    ds_read_b128 v[204:207], v4 offset:43008
    v_mfma_f32_16x16x32_bf16 v[36:39], v[208:211], v[116:119], v[36:39]
    v_mfma_f32_16x16x32_bf16 v[40:43], v[212:215], v[112:115], v[40:43]
    ds_read_b128 v[208:211], v5 offset:16384
    v_mfma_f32_16x16x32_bf16 v[44:47], v[212:215], v[116:119], v[44:47]
    v_mfma_f32_16x16x32_bf16 v[48:51], v[216:219], v[120:123], v[48:51]
    ds_read_b128 v[212:215], v5 offset:18432
    v_mfma_f32_16x16x32_bf16 v[52:55], v[216:219], v[124:127], v[52:55]
    v_mfma_f32_16x16x32_bf16 v[56:59], v[220:223], v[120:123], v[56:59]
    ds_read_b128 v[216:219], v5 offset:40960
    v_mfma_f32_16x16x32_bf16 v[60:63], v[220:223], v[124:127], v[60:63]
    s_barrier
    ds_read_b128 v[220:223], v5 offset:43008
    ds_read_b64_tr_b16 v[128:129], v12 offset:20480
    ds_read_b64_tr_b16 v[130:131], v12 offset:20992
    ds_read_b64_tr_b16 v[132:133], v13 offset:20480
    ds_read_b64_tr_b16 v[134:135], v13 offset:20992
    ds_read_b64_tr_b16 v[136:137], v12 offset:45056
    ds_read_b64_tr_b16 v[138:139], v12 offset:45568
    ds_read_b64_tr_b16 v[140:141], v13 offset:45056
    ds_read_b64_tr_b16 v[142:143], v13 offset:45568
    s_waitcnt lgkmcnt(8)
    s_barrier
    ds_read_b64_tr_b16 v[144:145], v12 offset:0
    ds_read_b64_tr_b16 v[146:147], v12 offset:512
    ds_read_b64_tr_b16 v[148:149], v13 offset:0
    ds_read_b64_tr_b16 v[150:151], v13 offset:512
    ds_read_b64_tr_b16 v[152:153], v12 offset:24576
    ds_read_b64_tr_b16 v[154:155], v12 offset:25088
    ds_read_b64_tr_b16 v[156:157], v13 offset:24576
    ds_read_b64_tr_b16 v[158:159], v13 offset:25088
    s_waitcnt lgkmcnt(8)
    s_barrier
L_slot2:
    v_mfma_f32_16x16x32_bf16 v[32:35], v[192:195], v[128:131], v[32:35]
    v_mfma_f32_16x16x32_bf16 v[36:39], v[192:195], v[132:135], v[36:39]
    v_mfma_f32_16x16x32_bf16 v[40:43], v[196:199], v[128:131], v[40:43]
    ds_read_b128 v[192:195], v4 offset:4096
    v_mfma_f32_16x16x32_bf16 v[44:47], v[196:199], v[132:135], v[44:47]
    v_mfma_f32_16x16x32_bf16 v[48:51], v[200:203], v[136:139], v[48:51]
    ds_read_b128 v[196:199], v4 offset:6144
    v_mfma_f32_16x16x32_bf16 v[52:55], v[200:203], v[140:143], v[52:55]
    v_mfma_f32_16x16x32_bf16 v[56:59], v[204:207], v[136:139], v[56:59]
    ds_read_b128 v[200:203], v4 offset:28672
    v_mfma_f32_16x16x32_bf16 v[60:63], v[204:207], v[140:143], v[60:63]
    s_waitcnt lgkmcnt(3)
    v_mfma_f32_16x16x32_bf16 v[32:35], v[208:211], v[144:147], v[32:35]
    ds_read_b128 v[204:207], v4 offset:30720
    v_mfma_f32_16x16x32_bf16 v[36:39], v[208:211], v[148:151], v[36:39]
    v_mfma_f32_16x16x32_bf16 v[40:43], v[212:215], v[144:147], v[40:43]
    ds_read_b128 v[208:211], v5 offset:4096
    v_mfma_f32_16x16x32_bf16 v[44:47], v[212:215], v[148:151], v[44:47]
    v_mfma_f32_16x16x32_bf16 v[48:51], v[216:219], v[152:155], v[48:51]
    ds_read_b128 v[212:215], v5 offset:6144
    v_mfma_f32_16x16x32_bf16 v[52:55], v[216:219], v[156:159], v[52:55]
    v_mfma_f32_16x16x32_bf16 v[56:59], v[220:223], v[152:155], v[56:59]
    ds_read_b128 v[216:219], v5 offset:28672
    v_mfma_f32_16x16x32_bf16 v[60:63], v[220:223], v[156:159], v[60:63]
    s_barrier
    ds_read_b128 v[220:223], v5 offset:30720
    ds_read_b64_tr_b16 v[160:161], v12 offset:8192
    ds_read_b64_tr_b16 v[162:163], v12 offset:8704
    ds_read_b64_tr_b16 v[164:165], v13 offset:8192
    ds_read_b64_tr_b16 v[166:167], v13 offset:8704
    ds_read_b64_tr_b16 v[168:169], v12 offset:32768
    ds_read_b64_tr_b16 v[170:171], v12 offset:33280
    ds_read_b64_tr_b16 v[172:173], v13 offset:32768
    ds_read_b64_tr_b16 v[174:175], v13 offset:33280
    s_waitcnt lgkmcnt(8)
    s_barrier
    ds_read_b64_tr_b16 v[176:177], v12 offset:12288
    ds_read_b64_tr_b16 v[178:179], v12 offset:12800
    ds_read_b64_tr_b16 v[180:181], v13 offset:12288
    ds_read_b64_tr_b16 v[182:183], v13 offset:12800
    ds_read_b64_tr_b16 v[184:185], v12 offset:36864
    ds_read_b64_tr_b16 v[186:187], v12 offset:37376
    ds_read_b64_tr_b16 v[188:189], v13 offset:36864
    ds_read_b64_tr_b16 v[190:191], v13 offset:37376
    s_waitcnt lgkmcnt(8)
    s_barrier
L_slot3:
    v_mfma_f32_16x16x32_bf16 v[32:35], v[192:195], v[160:163], v[32:35]
    v_mfma_f32_16x16x32_bf16 v[36:39], v[192:195], v[164:167], v[36:39]
    v_mfma_f32_16x16x32_bf16 v[40:43], v[196:199], v[160:163], v[40:43]
    ds_read_b128 v[192:195], v4 offset:16384
    v_mfma_f32_16x16x32_bf16 v[44:47], v[196:199], v[164:167], v[44:47]
    v_mfma_f32_16x16x32_bf16 v[48:51], v[200:203], v[168:171], v[48:51]
    ds_read_b128 v[196:199], v4 offset:18432
    v_mfma_f32_16x16x32_bf16 v[52:55], v[200:203], v[172:175], v[52:55]
    v_mfma_f32_16x16x32_bf16 v[56:59], v[204:207], v[168:171], v[56:59]
    ds_read_b128 v[200:203], v4 offset:40960
    v_mfma_f32_16x16x32_bf16 v[60:63], v[204:207], v[172:175], v[60:63]
    s_waitcnt lgkmcnt(3)
    v_mfma_f32_16x16x32_bf16 v[32:35], v[208:211], v[176:179], v[32:35]
    ds_read_b128 v[204:207], v4 offset:43008
    v_mfma_f32_16x16x32_bf16 v[36:39], v[208:211], v[180:183], v[36:39]
    v_mfma_f32_16x16x32_bf16 v[40:43], v[212:215], v[176:179], v[40:43]
    ds_read_b128 v[208:211], v5 offset:16384
    v_mfma_f32_16x16x32_bf16 v[44:47], v[212:215], v[180:183], v[44:47]
    v_mfma_f32_16x16x32_bf16 v[48:51], v[216:219], v[184:187], v[48:51]
    ds_read_b128 v[212:215], v5 offset:18432
    v_mfma_f32_16x16x32_bf16 v[52:55], v[216:219], v[188:191], v[52:55]
    v_mfma_f32_16x16x32_bf16 v[56:59], v[220:223], v[184:187], v[56:59]
    ds_read_b128 v[216:219], v5 offset:40960
    v_mfma_f32_16x16x32_bf16 v[60:63], v[220:223], v[188:191], v[60:63]
    s_barrier
L_slot4:
    s_waitcnt lgkmcnt(5)
    v_mfma_f32_16x16x32_bf16 v[64:67], v[192:195], v[224:227], 0
    ds_read_b128 v[220:223], v5 offset:43008
    v_add_u32 v0, s8, v3
    v_mfma_f32_16x16x32_bf16 v[68:71], v[192:195], v[228:231], 0
    ds_read_b128 v[16:19], v0 offset:0
    v_mfma_f32_16x16x32_bf16 v[72:75], v[196:199], v[224:227], 0
    ds_read_b128 v[192:195], v4 offset:20480
    v_mfma_f32_16x16x32_bf16 v[76:79], v[196:199], v[228:231], 0
    ds_read_b128 v[20:23], v0 offset:1024
    s_waitcnt lgkmcnt(7)
    v_mfma_f32_16x16x32_bf16 v[80:83], v[200:203], v[232:235], 0
    ds_read_b128 v[196:199], v4 offset:22528
    v_mfma_f32_16x16x32_bf16 v[84:87], v[200:203], v[236:239], 0
    ds_read_b128 v[24:27], v0 offset:2048
    v_mfma_f32_16x16x32_bf16 v[88:91], v[204:207], v[232:235], 0
    ds_read_b128 v[200:203], v4 offset:45056
    v_mfma_f32_16x16x32_bf16 v[92:95], v[204:207], v[236:239], 0
    ds_read_b128 v[28:31], v0 offset:3072
    s_waitcnt lgkmcnt(9)
    v_mfma_f32_16x16x32_bf16 v[64:67], v[208:211], v[240:243], v[64:67]
    ds_read_b128 v[204:207], v4 offset:47104
    v_mfma_f32_16x16x32_bf16 v[68:71], v[208:211], v[244:247], v[68:71]
    s_waitcnt lgkmcnt(1)
    v_xor_b32 v16, v6, v16
    v_xor_b32 v18, v7, v18
    v_mfma_f32_16x16x32_bf16 v[72:75], v[212:215], v[240:243], v[72:75]
    ds_read_b128 v[208:211], v5 offset:20480
    v_xor_b32 v20, v6, v20
    v_xor_b32 v22, v7, v22
    v_xor_b32 v24, v6, v24
    v_mfma_f32_16x16x32_bf16 v[76:79], v[212:215], v[244:247], v[76:79]
    v_xor_b32 v26, v7, v26
    v_xor_b32 v28, v6, v28
    v_xor_b32 v30, v7, v30
    v_mfma_f32_16x16x32_bf16 v[80:83], v[216:219], v[248:251], v[80:83]
    ds_read_b128 v[212:215], v5 offset:22528
    v_or3_b32 v1, v16, v18, v20
    v_or3_b32 v2, v22, v24, v26
    v_mfma_f32_16x16x32_bf16 v[84:87], v[216:219], v[252:255], v[84:87]
    v_or3_b32 v1, v1, v28, v30
    v_or_b32 v1, v1, v2
    v_mfma_f32_16x16x32_bf16 v[88:91], v[220:223], v[248:251], v[88:91]
    ds_read_b128 v[216:219], v5 offset:45056
    v_and_b32 v1, 0xc000c000, v1
    v_cmp_ne_u32 vcc, 0, v1
    v_mfma_f32_16x16x32_bf16 v[92:95], v[220:223], v[252:255], v[92:95]
    s_nop 1
    s_cbranch_vccnz L_p00_slow
L_p00_ok:
    s_barrier
L_slot5:
    v_mfma_f32_16x16x32_bf16 v[64:67], v[192:195], v[96:99], v[64:67]
    ds_read_b128 v[220:223], v5 offset:47104
    v_cvt_pk_bf16_f32 v32, v32, v33
    v_cvt_pk_bf16_f32 v33, v34, v35
    v_cvt_pk_bf16_f32 v34, v36, v37
    v_mfma_f32_16x16x32_bf16 v[68:71], v[192:195], v[100:103], v[68:71]
    v_cvt_pk_bf16_f32 v35, v38, v39
    v_cvt_pk_bf16_f32 v36, v40, v41
    v_cvt_pk_bf16_f32 v37, v42, v43
    v_mfma_f32_16x16x32_bf16 v[72:75], v[196:199], v[96:99], v[72:75]
    ds_read_b128 v[192:195], v4 offset:0
    v_cvt_pk_bf16_f32 v38, v44, v45
    v_cvt_pk_bf16_f32 v39, v46, v47
    v_mfma_f32_16x16x32_bf16 v[76:79], v[196:199], v[100:103], v[76:79]
    v_permlane16_swap_b32 v32, v34
    v_permlane16_swap_b32 v33, v35
    s_waitcnt lgkmcnt(5)
    v_mfma_f32_16x16x32_bf16 v[80:83], v[200:203], v[104:107], v[80:83]
    ds_read_b128 v[196:199], v4 offset:2048
    v_cvt_pk_bf16_f32 v40, v48, v49
    v_cvt_pk_bf16_f32 v41, v50, v51
    v_mfma_f32_16x16x32_bf16 v[84:87], v[200:203], v[108:111], v[84:87]
    v_cvt_pk_bf16_f32 v42, v52, v53
    v_cvt_pk_bf16_f32 v43, v54, v55
    v_mfma_f32_16x16x32_bf16 v[88:91], v[204:207], v[104:107], v[88:91]
    ds_read_b128 v[200:203], v4 offset:24576
    v_cvt_pk_bf16_f32 v44, v56, v57
    v_cvt_pk_bf16_f32 v45, v58, v59
    v_mfma_f32_16x16x32_bf16 v[92:95], v[204:207], v[108:111], v[92:95]
    v_cvt_pk_bf16_f32 v46, v60, v61
    v_cvt_pk_bf16_f32 v47, v62, v63
    s_waitcnt lgkmcnt(5)
    v_mfma_f32_16x16x32_bf16 v[64:67], v[208:211], v[112:115], v[64:67]
    ds_read_b128 v[204:207], v4 offset:26624
    v_mfma_f32_32x32x16_bf16 v[48:63], v[32:35], v[16:19], 0
    v_permlane16_swap_b32 v36, v38
    v_permlane16_swap_b32 v37, v39
    v_permlane16_swap_b32 v40, v42
    v_permlane16_swap_b32 v41, v43
    v_mfma_f32_32x32x16_bf16 v[48:63], v[36:39], v[20:23], v[48:63]
    v_permlane16_swap_b32 v44, v46
    v_permlane16_swap_b32 v45, v47
    v_mfma_f32_32x32x16_bf16 v[48:63], v[40:43], v[24:27], v[48:63]
    s_nop 0
    v_mfma_f32_32x32x16_bf16 v[48:63], v[44:47], v[28:31], v[48:63]
    v_mfma_f32_16x16x32_bf16 v[68:71], v[208:211], v[116:119], v[68:71]
    v_mfma_f32_16x16x32_bf16 v[72:75], v[212:215], v[112:115], v[72:75]
    ds_read_b128 v[208:211], v5 offset:0
    v_mfma_f32_16x16x32_bf16 v[76:79], v[212:215], v[116:119], v[76:79]
    s_waitcnt lgkmcnt(5)
    v_mfma_f32_16x16x32_bf16 v[80:83], v[216:219], v[120:123], v[80:83]
    ds_read_b128 v[212:215], v5 offset:2048
    v_mfma_f32_16x16x32_bf16 v[84:87], v[216:219], v[124:127], v[84:87]
    v_mfma_f32_16x16x32_bf16 v[88:91], v[220:223], v[120:123], v[88:91]
    ds_read_b128 v[216:219], v5 offset:24576
    v_mfma_f32_16x16x32_bf16 v[92:95], v[220:223], v[124:127], v[92:95]
    v_add_u32 v2, s7, v3
    s_barrier
L_slot6:
    ds_write_b128 v2, v[56:59] offset:0
    ds_write_b128 v2, v[60:63] offset:1024
    s_waitcnt lgkmcnt(7)
    v_mfma_f32_16x16x32_bf16 v[64:67], v[192:195], v[128:131], v[64:67]
    ds_read_b128 v[220:223], v5 offset:26624
    v_add_u32 v0, s8, v3
    v_mfma_f32_16x16x32_bf16 v[68:71], v[192:195], v[132:135], v[68:71]
    ds_read_b128 v[16:19], v0 offset:8192
    v_mfma_f32_16x16x32_bf16 v[72:75], v[196:199], v[128:131], v[72:75]
    ds_read_b128 v[192:195], v4 offset:4096
    v_mfma_f32_16x16x32_bf16 v[76:79], v[196:199], v[132:135], v[76:79]
    ds_read_b128 v[20:23], v0 offset:9216
    s_waitcnt lgkmcnt(9)
    v_mfma_f32_16x16x32_bf16 v[80:83], v[200:203], v[136:139], v[80:83]
    ds_read_b128 v[196:199], v4 offset:6144
    v_mfma_f32_16x16x32_bf16 v[84:87], v[200:203], v[140:143], v[84:87]
    ds_read_b128 v[24:27], v0 offset:10240
    v_mfma_f32_16x16x32_bf16 v[88:91], v[204:207], v[136:139], v[88:91]
    ds_read_b128 v[200:203], v4 offset:28672
    v_mfma_f32_16x16x32_bf16 v[92:95], v[204:207], v[140:143], v[92:95]
    ds_read_b128 v[28:31], v0 offset:11264
    s_waitcnt lgkmcnt(11)
    v_mfma_f32_16x16x32_bf16 v[64:67], v[208:211], v[144:147], v[64:67]
    ds_read_b128 v[204:207], v4 offset:30720
    v_mfma_f32_16x16x32_bf16 v[68:71], v[208:211], v[148:151], v[68:71]
    s_waitcnt lgkmcnt(1)
    v_xor_b32 v16, v6, v16
    v_xor_b32 v18, v7, v18
    v_mfma_f32_16x16x32_bf16 v[72:75], v[212:215], v[144:147], v[72:75]
    ds_read_b128 v[208:211], v5 offset:4096
    v_xor_b32 v20, v6, v20
    v_xor_b32 v22, v7, v22
    v_xor_b32 v24, v6, v24
    v_mfma_f32_16x16x32_bf16 v[76:79], v[212:215], v[148:151], v[76:79]
    v_xor_b32 v26, v7, v26
    v_xor_b32 v28, v6, v28
    v_xor_b32 v30, v7, v30
    v_mfma_f32_16x16x32_bf16 v[80:83], v[216:219], v[152:155], v[80:83]
    ds_read_b128 v[212:215], v5 offset:6144
    v_or3_b32 v1, v16, v18, v20
    v_or3_b32 v2, v22, v24, v26
    v_mfma_f32_16x16x32_bf16 v[84:87], v[216:219], v[156:159], v[84:87]
    v_or3_b32 v1, v1, v28, v30
    v_or_b32 v1, v1, v2
    v_mfma_f32_16x16x32_bf16 v[88:91], v[220:223], v[152:155], v[88:91]
    ds_read_b128 v[216:219], v5 offset:28672
    v_and_b32 v1, 0xc000c000, v1
    v_cmp_ne_u32 vcc, 0, v1
    v_mfma_f32_16x16x32_bf16 v[92:95], v[220:223], v[156:159], v[92:95]
    s_nop 1
    s_cbranch_vccnz L_p01_slow
L_p01_ok:
    s_barrier
L_slot7:
    v_mfma_f32_16x16x32_bf16 v[64:67], v[192:195], v[160:163], v[64:67]
    ds_read_b128 v[220:223], v5 offset:30720
    v_add_u32 v1, s6, v3
    v_mfma_f32_16x16x32_bf16 v[68:71], v[192:195], v[164:167], v[68:71]
    ds_read_b128 v[32:35], v1 offset:0
    v_mfma_f32_16x16x32_bf16 v[72:75], v[196:199], v[160:163], v[72:75]
    ds_read_b128 v[192:195], v4 offset:8192
    v_mfma_f32_16x16x32_bf16 v[76:79], v[196:199], v[164:167], v[76:79]
    ds_read_b128 v[36:39], v1 offset:1024
    s_waitcnt lgkmcnt(7)
    v_mfma_f32_16x16x32_bf16 v[80:83], v[200:203], v[168:171], v[80:83]
    ds_read_b128 v[196:199], v4 offset:10240
    v_mfma_f32_16x16x32_bf16 v[84:87], v[200:203], v[172:175], v[84:87]
    v_mfma_f32_16x16x32_bf16 v[88:91], v[204:207], v[168:171], v[88:91]
    ds_read_b128 v[200:203], v4 offset:32768
    v_mfma_f32_16x16x32_bf16 v[92:95], v[204:207], v[172:175], v[92:95]
    s_waitcnt lgkmcnt(7)
    v_mfma_f32_16x16x32_bf16 v[64:67], v[208:211], v[176:179], v[64:67]
    ds_read_b128 v[204:207], v4 offset:34816
    s_waitcnt lgkmcnt(3)
    v_add_f32 v8, v48, v32
    v_mfma_f32_16x16x32_bf16 v[68:71], v[208:211], v[180:183], v[68:71]
    v_add_f32 v9, v49, v33
    v_add_f32 v10, v50, v34
    v_mfma_f32_16x16x32_bf16 v[72:75], v[212:215], v[176:179], v[72:75]
    ds_read_b128 v[208:211], v5 offset:8192
    v_add_f32 v11, v51, v35
    v_add_f32 v12, v52, v36
    v_mfma_f32_16x16x32_bf16 v[76:79], v[212:215], v[180:183], v[76:79]
    v_add_f32 v13, v53, v37
    v_mfma_f32_16x16x32_bf16 v[80:83], v[216:219], v[184:187], v[80:83]
    ds_read_b128 v[212:215], v5 offset:10240
    v_add_f32 v14, v54, v38
    v_mfma_f32_16x16x32_bf16 v[84:87], v[216:219], v[188:191], v[84:87]
    v_add_f32 v15, v55, v39
    v_mfma_f32_16x16x32_bf16 v[88:91], v[220:223], v[184:187], v[88:91]
    ds_read_b128 v[216:219], v5 offset:32768
    v_mfma_f32_16x16x32_bf16 v[92:95], v[220:223], v[188:191], v[92:95]
    s_barrier
L_slot8:
    s_waitcnt lgkmcnt(5)
    v_mfma_f32_16x16x32_bf16 v[32:35], v[192:195], v[224:227], 0
    ds_read_b128 v[220:223], v5 offset:34816
    v_mfma_f32_16x16x32_bf16 v[36:39], v[192:195], v[228:231], 0
    v_mfma_f32_16x16x32_bf16 v[40:43], v[196:199], v[224:227], 0
    ds_read_b128 v[192:195], v4 offset:12288
    v_cvt_pk_bf16_f32 v64, v64, v65
    v_cvt_pk_bf16_f32 v65, v66, v67
    v_cvt_pk_bf16_f32 v66, v68, v69
    v_mfma_f32_16x16x32_bf16 v[44:47], v[196:199], v[228:231], 0
    v_cvt_pk_bf16_f32 v67, v70, v71
    v_cvt_pk_bf16_f32 v68, v72, v73
    v_cvt_pk_bf16_f32 v69, v74, v75
    s_waitcnt lgkmcnt(5)
    v_mfma_f32_16x16x32_bf16 v[48:51], v[200:203], v[232:235], 0
    ds_read_b128 v[196:199], v4 offset:14336
    v_cvt_pk_bf16_f32 v70, v76, v77
    v_cvt_pk_bf16_f32 v71, v78, v79
    v_mfma_f32_16x16x32_bf16 v[52:55], v[200:203], v[236:239], 0
    v_permlane16_swap_b32 v64, v66
    v_permlane16_swap_b32 v65, v67
    v_mfma_f32_16x16x32_bf16 v[56:59], v[204:207], v[232:235], 0
    ds_read_b128 v[200:203], v4 offset:36864
    v_cvt_pk_bf16_f32 v72, v80, v81
    v_cvt_pk_bf16_f32 v73, v82, v83
    v_mfma_f32_16x16x32_bf16 v[60:63], v[204:207], v[236:239], 0
    v_cvt_pk_bf16_f32 v74, v84, v85
    v_cvt_pk_bf16_f32 v75, v86, v87
    s_waitcnt lgkmcnt(5)
    v_mfma_f32_16x16x32_bf16 v[32:35], v[208:211], v[240:243], v[32:35]
    ds_read_b128 v[204:207], v4 offset:38912
    v_cvt_pk_bf16_f32 v76, v88, v89
    v_cvt_pk_bf16_f32 v77, v90, v91
    v_mfma_f32_16x16x32_bf16 v[36:39], v[208:211], v[244:247], v[36:39]
    v_cvt_pk_bf16_f32 v78, v92, v93
    v_cvt_pk_bf16_f32 v79, v94, v95
    v_mfma_f32_16x16x32_bf16 v[40:43], v[212:215], v[240:243], v[40:43]
    ds_read_b128 v[208:211], v5 offset:12288
    v_mfma_f32_32x32x16_bf16 v[80:95], v[64:67], v[16:19], 0
    v_permlane16_swap_b32 v68, v70
    v_permlane16_swap_b32 v69, v71
    v_permlane16_swap_b32 v72, v74
    v_permlane16_swap_b32 v73, v75
    v_mfma_f32_32x32x16_bf16 v[80:95], v[68:71], v[20:23], v[80:95]
    v_permlane16_swap_b32 v76, v78
    v_permlane16_swap_b32 v77, v79
    v_mfma_f32_32x32x16_bf16 v[80:95], v[72:75], v[24:27], v[80:95]
    s_nop 0
    v_mfma_f32_32x32x16_bf16 v[80:95], v[76:79], v[28:31], v[80:95]
    v_mfma_f32_16x16x32_bf16 v[44:47], v[212:215], v[244:247], v[44:47]
    s_waitcnt lgkmcnt(5)
    v_mfma_f32_16x16x32_bf16 v[48:51], v[216:219], v[248:251], v[48:51]
    ds_read_b128 v[212:215], v5 offset:14336
    v_mfma_f32_16x16x32_bf16 v[52:55], v[216:219], v[252:255], v[52:55]
    v_mfma_f32_16x16x32_bf16 v[56:59], v[220:223], v[248:251], v[56:59]
    ds_read_b128 v[216:219], v5 offset:36864
    v_mfma_f32_16x16x32_bf16 v[60:63], v[220:223], v[252:255], v[60:63]
    v_add_u32 v2, s7, v3
    s_barrier
L_slot9:
    s_nop 1
    ds_write_b128 v2, v[88:91] offset:8192
    ds_write_b128 v2, v[92:95] offset:9216
    s_waitcnt lgkmcnt(7)
    v_mfma_f32_16x16x32_bf16 v[32:35], v[192:195], v[96:99], v[32:35]
    ds_read_b128 v[220:223], v5 offset:38912
    v_add_u32 v0, s8, v3
    v_mfma_f32_16x16x32_bf16 v[36:39], v[192:195], v[100:103], v[36:39]
    ds_read_b128 v[16:19], v0 offset:16384
    v_mfma_f32_16x16x32_bf16 v[40:43], v[196:199], v[96:99], v[40:43]
    ds_read_b128 v[192:195], v4 offset:16384
    v_mfma_f32_16x16x32_bf16 v[44:47], v[196:199], v[100:103], v[44:47]
    ds_read_b128 v[20:23], v0 offset:17408
    s_waitcnt lgkmcnt(9)
    v_mfma_f32_16x16x32_bf16 v[48:51], v[200:203], v[104:107], v[48:51]
    ds_read_b128 v[196:199], v4 offset:18432
    v_mfma_f32_16x16x32_bf16 v[52:55], v[200:203], v[108:111], v[52:55]
    ds_read_b128 v[24:27], v0 offset:18432
    v_mfma_f32_16x16x32_bf16 v[56:59], v[204:207], v[104:107], v[56:59]
    ds_read_b128 v[200:203], v4 offset:40960
    v_mfma_f32_16x16x32_bf16 v[60:63], v[204:207], v[108:111], v[60:63]
    ds_read_b128 v[28:31], v0 offset:19456
    s_waitcnt lgkmcnt(11)
    v_mfma_f32_16x16x32_bf16 v[32:35], v[208:211], v[112:115], v[32:35]
    ds_read_b128 v[204:207], v4 offset:43008
    v_mfma_f32_16x16x32_bf16 v[36:39], v[208:211], v[116:119], v[36:39]
    s_waitcnt lgkmcnt(1)
    v_xor_b32 v16, v6, v16
    v_xor_b32 v18, v7, v18
    v_mfma_f32_16x16x32_bf16 v[40:43], v[212:215], v[112:115], v[40:43]
    ds_read_b128 v[208:211], v5 offset:16384
    v_xor_b32 v20, v6, v20
    v_xor_b32 v22, v7, v22
    v_xor_b32 v24, v6, v24
    v_mfma_f32_16x16x32_bf16 v[44:47], v[212:215], v[116:119], v[44:47]
    v_xor_b32 v26, v7, v26
    v_xor_b32 v28, v6, v28
    v_xor_b32 v30, v7, v30
    v_mfma_f32_16x16x32_bf16 v[48:51], v[216:219], v[120:123], v[48:51]
    ds_read_b128 v[212:215], v5 offset:18432
    v_or3_b32 v1, v16, v18, v20
    v_or3_b32 v2, v22, v24, v26
    v_mfma_f32_16x16x32_bf16 v[52:55], v[216:219], v[124:127], v[52:55]
    v_or3_b32 v1, v1, v28, v30
    v_or_b32 v1, v1, v2
    v_mfma_f32_16x16x32_bf16 v[56:59], v[220:223], v[120:123], v[56:59]
    ds_read_b128 v[216:219], v5 offset:40960
    v_and_b32 v1, 0xc000c000, v1
    v_cmp_ne_u32 vcc, 0, v1
    v_mfma_f32_16x16x32_bf16 v[60:63], v[220:223], v[124:127], v[60:63]
    s_nop 1
    s_cbranch_vccnz L_p02_slow
L_p02_ok:
    s_barrier
L_slot10:
    v_mfma_f32_16x16x32_bf16 v[32:35], v[192:195], v[128:131], v[32:35]
    ds_read_b128 v[220:223], v5 offset:43008
    v_add_u32 v1, s6, v3
    v_mfma_f32_16x16x32_bf16 v[36:39], v[192:195], v[132:135], v[36:39]
    ds_read_b128 v[64:67], v1 offset:8192
    v_mfma_f32_16x16x32_bf16 v[40:43], v[196:199], v[128:131], v[40:43]
    ds_read_b128 v[192:195], v4 offset:20480
    v_mfma_f32_16x16x32_bf16 v[44:47], v[196:199], v[132:135], v[44:47]
    ds_read_b128 v[68:71], v1 offset:9216
    s_waitcnt lgkmcnt(7)
    v_mfma_f32_16x16x32_bf16 v[48:51], v[200:203], v[136:139], v[48:51]
    ds_read_b128 v[196:199], v4 offset:22528
    v_mfma_f32_16x16x32_bf16 v[52:55], v[200:203], v[140:143], v[52:55]
    v_mfma_f32_16x16x32_bf16 v[56:59], v[204:207], v[136:139], v[56:59]
    ds_read_b128 v[200:203], v4 offset:45056
    v_mfma_f32_16x16x32_bf16 v[60:63], v[204:207], v[140:143], v[60:63]
    s_waitcnt lgkmcnt(7)
    v_mfma_f32_16x16x32_bf16 v[32:35], v[208:211], v[144:147], v[32:35]
    ds_read_b128 v[204:207], v4 offset:47104
    s_waitcnt lgkmcnt(3)
    v_add_f32 v80, v80, v64
    v_mfma_f32_16x16x32_bf16 v[36:39], v[208:211], v[148:151], v[36:39]
    v_add_f32 v81, v81, v65
    v_add_f32 v82, v82, v66
    v_mfma_f32_16x16x32_bf16 v[40:43], v[212:215], v[144:147], v[40:43]
    ds_read_b128 v[208:211], v5 offset:20480
    v_add_f32 v83, v83, v67
    v_add_f32 v84, v84, v68
    v_mfma_f32_16x16x32_bf16 v[44:47], v[212:215], v[148:151], v[44:47]
    v_add_f32 v85, v85, v69
    v_mfma_f32_16x16x32_bf16 v[48:51], v[216:219], v[152:155], v[48:51]
    ds_read_b128 v[212:215], v5 offset:22528
    v_add_f32 v86, v86, v70
    v_mfma_f32_16x16x32_bf16 v[52:55], v[216:219], v[156:159], v[52:55]
    v_add_f32 v87, v87, v71
    v_mfma_f32_16x16x32_bf16 v[56:59], v[220:223], v[152:155], v[56:59]
    ds_read_b128 v[216:219], v5 offset:45056
    v_mfma_f32_16x16x32_bf16 v[60:63], v[220:223], v[156:159], v[60:63]
    s_barrier
L_slot11:
    s_waitcnt lgkmcnt(5)
    v_mfma_f32_16x16x32_bf16 v[32:35], v[192:195], v[160:163], v[32:35]
    ds_read_b128 v[220:223], v5 offset:47104
    v_mfma_f32_16x16x32_bf16 v[36:39], v[192:195], v[164:167], v[36:39]
    v_mul_u32_u24 v0, 0xfa7519, v3
    v_bfe_u32 v0, v0, 12, 8
    v_mfma_f32_16x16x32_bf16 v[40:43], v[196:199], v[160:163], v[40:43]
    ds_read_b128 v[192:195], v4 offset:0
    v_xor_b32 v0, s64, v0
    v_mfma_f32_16x16x32_bf16 v[44:47], v[196:199], v[164:167], v[44:47]
    v_and_or_b32 v8, v8, s60, v0
    buffer_store_dwordx4 v[8:11], v3, s[40:43], s12 offen offset:0 sc1
    s_waitcnt lgkmcnt(5)
    v_mfma_f32_16x16x32_bf16 v[48:51], v[200:203], v[168:171], v[48:51]
    ds_read_b128 v[196:199], v4 offset:2048
    v_mfma_f32_16x16x32_bf16 v[52:55], v[200:203], v[172:175], v[52:55]
    v_mfma_f32_16x16x32_bf16 v[56:59], v[204:207], v[168:171], v[56:59]
    ds_read_b128 v[200:203], v4 offset:24576
    v_mfma_f32_16x16x32_bf16 v[60:63], v[204:207], v[172:175], v[60:63]
    v_and_or_b32 v12, v12, s60, v0
    buffer_store_dwordx4 v[12:15], v3, s[40:43], s12 offen offset:1024 sc1
    s_waitcnt lgkmcnt(5)
    v_mfma_f32_16x16x32_bf16 v[32:35], v[208:211], v[176:179], v[32:35]
    ds_read_b128 v[204:207], v4 offset:26624
    v_mfma_f32_16x16x32_bf16 v[36:39], v[208:211], v[180:183], v[36:39]
    v_mfma_f32_16x16x32_bf16 v[40:43], v[212:215], v[176:179], v[40:43]
    ds_read_b128 v[208:211], v5 offset:0
    v_mfma_f32_16x16x32_bf16 v[44:47], v[212:215], v[180:183], v[44:47]
    v_and_or_b32 v80, v80, s60, v0
    buffer_store_dwordx4 v[80:83], v3, s[40:43], s13 offen offset:0 sc1
    s_waitcnt lgkmcnt(5)
    v_mfma_f32_16x16x32_bf16 v[48:51], v[216:219], v[184:187], v[48:51]
    ds_read_b128 v[212:215], v5 offset:2048
    v_mfma_f32_16x16x32_bf16 v[52:55], v[216:219], v[188:191], v[52:55]
    v_mfma_f32_16x16x32_bf16 v[56:59], v[220:223], v[184:187], v[56:59]
    ds_read_b128 v[216:219], v5 offset:24576
    v_mfma_f32_16x16x32_bf16 v[60:63], v[220:223], v[188:191], v[60:63]
    v_and_or_b32 v84, v84, s60, v0
    buffer_store_dwordx4 v[84:87], v3, s[40:43], s13 offen offset:1024 sc1
    s_barrier
L_slot12:
    s_waitcnt lgkmcnt(5)
    v_mfma_f32_16x16x32_bf16 v[64:67], v[192:195], v[224:227], 0
    ds_read_b128 v[220:223], v5 offset:26624
    v_mfma_f32_16x16x32_bf16 v[68:71], v[192:195], v[228:231], 0
    v_mfma_f32_16x16x32_bf16 v[72:75], v[196:199], v[224:227], 0
    ds_read_b128 v[192:195], v4 offset:4096
    v_cvt_pk_bf16_f32 v32, v32, v33
    v_cvt_pk_bf16_f32 v33, v34, v35
    v_cvt_pk_bf16_f32 v34, v36, v37
    v_cvt_pk_bf16_f32 v35, v38, v39
    v_mfma_f32_16x16x32_bf16 v[76:79], v[196:199], v[228:231], 0
    v_cvt_pk_bf16_f32 v36, v40, v41
    v_cvt_pk_bf16_f32 v37, v42, v43
    v_cvt_pk_bf16_f32 v38, v44, v45
    v_cvt_pk_bf16_f32 v39, v46, v47
    s_waitcnt lgkmcnt(5)
    v_mfma_f32_16x16x32_bf16 v[80:83], v[200:203], v[232:235], 0
    ds_read_b128 v[196:199], v4 offset:6144
    v_permlane16_swap_b32 v32, v34
    v_permlane16_swap_b32 v33, v35
    v_cvt_pk_bf16_f32 v40, v48, v49
    v_cvt_pk_bf16_f32 v41, v50, v51
    v_mfma_f32_16x16x32_bf16 v[84:87], v[200:203], v[236:239], 0
    v_cvt_pk_bf16_f32 v42, v52, v53
    v_cvt_pk_bf16_f32 v43, v54, v55
    v_cvt_pk_bf16_f32 v44, v56, v57
    v_mfma_f32_16x16x32_bf16 v[88:91], v[204:207], v[232:235], 0
    ds_read_b128 v[200:203], v4 offset:28672
    v_cvt_pk_bf16_f32 v45, v58, v59
    v_cvt_pk_bf16_f32 v46, v60, v61
    v_cvt_pk_bf16_f32 v47, v62, v63
    v_mfma_f32_16x16x32_bf16 v[92:95], v[204:207], v[236:239], 0
    v_mfma_f32_32x32x16_bf16 v[48:63], v[32:35], v[16:19], 0
    v_permlane16_swap_b32 v36, v38
    v_permlane16_swap_b32 v37, v39
    v_permlane16_swap_b32 v40, v42
    v_permlane16_swap_b32 v41, v43
    v_mfma_f32_32x32x16_bf16 v[48:63], v[36:39], v[20:23], v[48:63]
    v_permlane16_swap_b32 v44, v46
    v_permlane16_swap_b32 v45, v47
    v_mfma_f32_32x32x16_bf16 v[48:63], v[40:43], v[24:27], v[48:63]
    s_nop 0
    v_mfma_f32_32x32x16_bf16 v[48:63], v[44:47], v[28:31], v[48:63]
    s_waitcnt lgkmcnt(5)
    v_mfma_f32_16x16x32_bf16 v[64:67], v[208:211], v[240:243], v[64:67]
    ds_read_b128 v[204:207], v4 offset:30720
    v_mfma_f32_16x16x32_bf16 v[68:71], v[208:211], v[244:247], v[68:71]
    v_mfma_f32_16x16x32_bf16 v[72:75], v[212:215], v[240:243], v[72:75]
    ds_read_b128 v[208:211], v5 offset:4096
    v_mfma_f32_16x16x32_bf16 v[76:79], v[212:215], v[244:247], v[76:79]
    s_waitcnt lgkmcnt(5)
    v_mfma_f32_16x16x32_bf16 v[80:83], v[216:219], v[248:251], v[80:83]
    ds_read_b128 v[212:215], v5 offset:6144
    v_mfma_f32_16x16x32_bf16 v[84:87], v[216:219], v[252:255], v[84:87]
    v_add_u32 v2, s7, v3
    ds_write_b128 v2, v[56:59] offset:0
    ds_write_b128 v2, v[60:63] offset:1024
    v_mfma_f32_16x16x32_bf16 v[88:91], v[220:223], v[248:251], v[88:91]
    ds_read_b128 v[216:219], v5 offset:28672
    v_mfma_f32_16x16x32_bf16 v[92:95], v[220:223], v[252:255], v[92:95]
    s_waitcnt lgkmcnt(1)
    s_barrier
L_slot13:
    v_mfma_f32_16x16x32_bf16 v[64:67], v[192:195], v[96:99], v[64:67]
    v_add_u32 v1, s6, v3
    ds_read_b128 v[32:35], v1 offset:0
    ds_read_b128 v[36:39], v1 offset:1024
    ds_read_b128 v[220:223], v5 offset:30720
    v_mfma_f32_16x16x32_bf16 v[68:71], v[192:195], v[100:103], v[68:71]
    v_mul_u32_u24 v0, 0xfa7519, v3
    v_mfma_f32_16x16x32_bf16 v[72:75], v[196:199], v[96:99], v[72:75]
    ds_read_b128 v[192:195], v4 offset:8192
    v_bfe_u32 v0, v0, 12, 8
    v_mfma_f32_16x16x32_bf16 v[76:79], v[196:199], v[100:103], v[76:79]
    v_xor_b32 v0, s64, v0
    v_mfma_f32_16x16x32_bf16 v[80:83], v[200:203], v[104:107], v[80:83]
    ds_read_b128 v[196:199], v4 offset:10240
    s_waitcnt lgkmcnt(3)
    v_add_f32 v48, v48, v32
    v_add_f32 v49, v49, v33
    v_mfma_f32_16x16x32_bf16 v[84:87], v[200:203], v[108:111], v[84:87]
    v_add_f32 v50, v50, v34
    v_add_f32 v51, v51, v35
    v_and_or_b32 v48, v48, s60, v0
    buffer_store_dwordx4 v[48:51], v3, s[40:43], s14 offen offset:0 sc1
    v_mfma_f32_16x16x32_bf16 v[88:91], v[204:207], v[104:107], v[88:91]
    ds_read_b128 v[200:203], v4 offset:32768
    v_add_f32 v52, v52, v36
    v_add_f32 v53, v53, v37
    v_mfma_f32_16x16x32_bf16 v[92:95], v[204:207], v[108:111], v[92:95]
    v_add_f32 v54, v54, v38
    v_add_f32 v55, v55, v39
    v_and_or_b32 v52, v52, s60, v0
    buffer_store_dwordx4 v[52:55], v3, s[40:43], s14 offen offset:1024 sc1
    v_mfma_f32_16x16x32_bf16 v[64:67], v[208:211], v[112:115], v[64:67]
    ds_read_b128 v[204:207], v4 offset:34816
    v_mfma_f32_16x16x32_bf16 v[68:71], v[208:211], v[116:119], v[68:71]
    v_mfma_f32_16x16x32_bf16 v[72:75], v[212:215], v[112:115], v[72:75]
    ds_read_b128 v[208:211], v5 offset:8192
    v_mfma_f32_16x16x32_bf16 v[76:79], v[212:215], v[116:119], v[76:79]
    s_waitcnt lgkmcnt(5)
    v_mfma_f32_16x16x32_bf16 v[80:83], v[216:219], v[120:123], v[80:83]
    ds_read_b128 v[212:215], v5 offset:10240
    v_mfma_f32_16x16x32_bf16 v[84:87], v[216:219], v[124:127], v[84:87]
    v_mfma_f32_16x16x32_bf16 v[88:91], v[220:223], v[120:123], v[88:91]
    ds_read_b128 v[216:219], v5 offset:32768
    v_mfma_f32_16x16x32_bf16 v[92:95], v[220:223], v[124:127], v[92:95]
    s_barrier
L_slot14:
    s_waitcnt lgkmcnt(5)
    v_mfma_f32_16x16x32_bf16 v[64:67], v[192:195], v[128:131], v[64:67]
    ds_read_b128 v[220:223], v5 offset:34816
    v_add_u32 v0, s8, v3
    v_mfma_f32_16x16x32_bf16 v[68:71], v[192:195], v[132:135], v[68:71]
    ds_read_b128 v[16:19], v0 offset:24576
    v_mfma_f32_16x16x32_bf16 v[72:75], v[196:199], v[128:131], v[72:75]
    ds_read_b128 v[192:195], v4 offset:12288
    v_mfma_f32_16x16x32_bf16 v[76:79], v[196:199], v[132:135], v[76:79]
    ds_read_b128 v[20:23], v0 offset:25600
    s_waitcnt lgkmcnt(7)
    v_mfma_f32_16x16x32_bf16 v[80:83], v[200:203], v[136:139], v[80:83]
    ds_read_b128 v[196:199], v4 offset:14336
    v_mfma_f32_16x16x32_bf16 v[84:87], v[200:203], v[140:143], v[84:87]
    ds_read_b128 v[24:27], v0 offset:26624
    v_mfma_f32_16x16x32_bf16 v[88:91], v[204:207], v[136:139], v[88:91]
    ds_read_b128 v[200:203], v4 offset:36864
    v_mfma_f32_16x16x32_bf16 v[92:95], v[204:207], v[140:143], v[92:95]
    ds_read_b128 v[28:31], v0 offset:27648
    s_waitcnt lgkmcnt(9)
    v_mfma_f32_16x16x32_bf16 v[64:67], v[208:211], v[144:147], v[64:67]
    ds_read_b128 v[204:207], v4 offset:38912
    v_mfma_f32_16x16x32_bf16 v[68:71], v[208:211], v[148:151], v[68:71]
    s_waitcnt lgkmcnt(1)
    v_xor_b32 v16, v6, v16
    v_xor_b32 v18, v7, v18
    v_mfma_f32_16x16x32_bf16 v[72:75], v[212:215], v[144:147], v[72:75]
    ds_read_b128 v[208:211], v5 offset:12288
    v_xor_b32 v20, v6, v20
    v_xor_b32 v22, v7, v22
    v_xor_b32 v24, v6, v24
    v_mfma_f32_16x16x32_bf16 v[76:79], v[212:215], v[148:151], v[76:79]
    v_xor_b32 v26, v7, v26
    v_xor_b32 v28, v6, v28
    v_xor_b32 v30, v7, v30
    v_mfma_f32_16x16x32_bf16 v[80:83], v[216:219], v[152:155], v[80:83]
    ds_read_b128 v[212:215], v5 offset:14336
    v_or3_b32 v1, v16, v18, v20
    v_or3_b32 v2, v22, v24, v26
    v_mfma_f32_16x16x32_bf16 v[84:87], v[216:219], v[156:159], v[84:87]
    v_or3_b32 v1, v1, v28, v30
    v_or_b32 v1, v1, v2
    v_mfma_f32_16x16x32_bf16 v[88:91], v[220:223], v[152:155], v[88:91]
    ds_read_b128 v[216:219], v5 offset:36864
    v_and_b32 v1, 0xc000c000, v1
    v_cmp_ne_u32 vcc, 0, v1
    v_mfma_f32_16x16x32_bf16 v[92:95], v[220:223], v[156:159], v[92:95]
    s_nop 1
    s_cbranch_vccnz L_p03_slow
L_p03_ok:
    buffer_load_dwordx4 v[32:35], v3, s[40:43], s15 offen offset:0 sc1
    buffer_load_dwordx4 v[36:39], v3, s[40:43], s15 offen offset:1024 sc1
    buffer_load_dwordx4 v[40:43], v3, s[40:43], s16 offen offset:0 sc1
    buffer_load_dwordx4 v[44:47], v3, s[40:43], s16 offen offset:1024 sc1
    buffer_load_dwordx4 v[56:59], v3, s[40:43], s17 offen offset:0 sc1
    buffer_load_dwordx4 v[60:63], v3, s[40:43], s17 offen offset:1024 sc1
L_slot15:
    v_mfma_f32_16x16x32_bf16 v[64:67], v[192:195], v[160:163], v[64:67]
    ds_read_b128 v[220:223], v5 offset:38912
    v_mfma_f32_16x16x32_bf16 v[68:71], v[192:195], v[164:167], v[68:71]
    v_mfma_f32_16x16x32_bf16 v[72:75], v[196:199], v[160:163], v[72:75]
    v_mfma_f32_16x16x32_bf16 v[76:79], v[196:199], v[164:167], v[76:79]
    s_waitcnt lgkmcnt(4)
    v_mfma_f32_16x16x32_bf16 v[80:83], v[200:203], v[168:171], v[80:83]
    v_mfma_f32_16x16x32_bf16 v[84:87], v[200:203], v[172:175], v[84:87]
    v_mfma_f32_16x16x32_bf16 v[88:91], v[204:207], v[168:171], v[88:91]
    v_mfma_f32_16x16x32_bf16 v[92:95], v[204:207], v[172:175], v[92:95]
    s_waitcnt lgkmcnt(2)
    v_mfma_f32_16x16x32_bf16 v[64:67], v[208:211], v[176:179], v[64:67]
    v_mfma_f32_16x16x32_bf16 v[68:71], v[208:211], v[180:183], v[68:71]
    v_mfma_f32_16x16x32_bf16 v[72:75], v[212:215], v[176:179], v[72:75]
    v_mfma_f32_16x16x32_bf16 v[76:79], v[212:215], v[180:183], v[76:79]
    s_waitcnt lgkmcnt(0)
    v_mfma_f32_16x16x32_bf16 v[80:83], v[216:219], v[184:187], v[80:83]
    v_mfma_f32_16x16x32_bf16 v[84:87], v[216:219], v[188:191], v[84:87]
    v_mfma_f32_16x16x32_bf16 v[88:91], v[220:223], v[184:187], v[88:91]
    v_mfma_f32_16x16x32_bf16 v[92:95], v[220:223], v[188:191], v[92:95]
    v_and_b32 v2, 0x1f0, v3
    v_mul_u32_u24 v2, 56, v2
    v_lshrrev_b32 v1, 9, v3
    v_lshl_add_u32 v4, v1, 4, v2
    v_cvt_pk_bf16_f32 v64, v64, v65
    v_cvt_pk_bf16_f32 v65, v66, v67
    v_cvt_pk_bf16_f32 v66, v68, v69
    v_cvt_pk_bf16_f32 v67, v70, v71
    v_cvt_pk_bf16_f32 v68, v72, v73
    v_cvt_pk_bf16_f32 v69, v74, v75
    v_cvt_pk_bf16_f32 v70, v76, v77
    v_cvt_pk_bf16_f32 v71, v78, v79
    v_permlane16_swap_b32 v64, v66
    v_permlane16_swap_b32 v65, v67
    v_cvt_pk_bf16_f32 v72, v80, v81
    v_cvt_pk_bf16_f32 v73, v82, v83
    v_cvt_pk_bf16_f32 v74, v84, v85
    v_cvt_pk_bf16_f32 v75, v86, v87
    v_cvt_pk_bf16_f32 v76, v88, v89
    v_cvt_pk_bf16_f32 v77, v90, v91
    v_cvt_pk_bf16_f32 v78, v92, v93
    v_cvt_pk_bf16_f32 v79, v94, v95
    v_mfma_f32_32x32x16_bf16 v[80:95], v[64:67], v[16:19], 0
    v_permlane16_swap_b32 v68, v70
    v_permlane16_swap_b32 v69, v71
    v_permlane16_swap_b32 v72, v74
    v_permlane16_swap_b32 v73, v75
    v_mfma_f32_32x32x16_bf16 v[80:95], v[68:71], v[20:23], v[80:95]
    v_permlane16_swap_b32 v76, v78
    v_permlane16_swap_b32 v77, v79
    v_mfma_f32_32x32x16_bf16 v[80:95], v[72:75], v[24:27], v[80:95]
    s_nop 0
    v_mfma_f32_32x32x16_bf16 v[80:95], v[76:79], v[28:31], v[80:95]
    v_add_u32 v2, s7, v3
    s_nop 10
    ds_write_b128 v2, v[88:91] offset:8192
    ds_write_b128 v2, v[92:95] offset:9216
    s_waitcnt lgkmcnt(0)
    s_barrier
    v_add_u32 v1, s6, v3
    ds_read_b128 v[64:67], v1 offset:8192
    ds_read_b128 v[68:71], v1 offset:9216
    v_mul_u32_u24 v0, 0xfa7519, v3
    v_bfe_u32 v0, v0, 12, 8
    v_xor_b32 v0, s64, v0
    s_waitcnt lgkmcnt(0)
    v_pk_add_f32 v[80:81], v[80:81], v[64:65]
    v_pk_add_f32 v[82:83], v[82:83], v[66:67]
    v_pk_add_f32 v[84:85], v[84:85], v[68:69]
    v_pk_add_f32 v[86:87], v[86:87], v[70:71]
    s_waitcnt vmcnt(0)
    v_xor_b32 v32, v0, v32
    v_xor_b32 v36, v0, v36
    v_xor_b32 v40, v0, v40
    v_xor_b32 v44, v0, v44
    v_xor_b32 v56, v0, v56
    v_xor_b32 v60, v0, v60
    v_or3_b32 v1, v32, v36, v40
    v_or3_b32 v2, v44, v56, v60
    v_or_b32 v1, v1, v2
    v_and_b32 v1, 0xff, v1
    v_cmp_ne_u32 vcc, 0, v1
    s_nop 1
    s_cbranch_vccnz L_g0_slow
L_g0_ok:
    v_pk_add_f32 v[32:33], v[32:33], v[40:41]
    v_pk_add_f32 v[34:35], v[34:35], v[42:43]
    v_pk_add_f32 v[36:37], v[36:37], v[44:45]
    v_pk_add_f32 v[38:39], v[38:39], v[46:47]
    v_pk_add_f32 v[80:81], v[80:81], v[56:57]
    v_pk_add_f32 v[82:83], v[82:83], v[58:59]
    v_pk_add_f32 v[84:85], v[84:85], v[60:61]
    v_pk_add_f32 v[86:87], v[86:87], v[62:63]
    v_pk_add_f32 v[80:81], v[80:81], v[32:33]
    v_pk_add_f32 v[82:83], v[82:83], v[34:35]
    v_pk_add_f32 v[84:85], v[84:85], v[36:37]
    v_pk_add_f32 v[86:87], v[86:87], v[38:39]
    v_cvt_pk_bf16_f32 v64, v80, v81
    v_cvt_pk_bf16_f32 v65, v82, v83
    v_cvt_pk_bf16_f32 v66, v84, v85
    v_cvt_pk_bf16_f32 v67, v86, v87
    s_nop 1
    v_permlane32_swap_b32 v64, v66
    v_permlane32_swap_b32 v65, v67
    s_nop 1
    buffer_store_dwordx4 v[64:67], v4, s[44:47], s5 offen
    s_endpgm
L_spare0:
    ds_read_b128 v[80:83], v9 offset:0
    ds_read_b128 v[84:87], v9 offset:1024
    ds_read_b128 v[88:91], v9 offset:2048
    ds_read_b128 v[92:95], v9 offset:3072
    s_waitcnt lgkmcnt(3)
    v_pk_add_f32 v[144:145], v[144:145], v[80:81]
    v_pk_add_f32 v[146:147], v[146:147], v[82:83]
    s_waitcnt lgkmcnt(2)
    v_pk_add_f32 v[148:149], v[148:149], v[84:85]
    v_pk_add_f32 v[150:151], v[150:151], v[86:87]
    s_waitcnt lgkmcnt(1)
    v_pk_add_f32 v[152:153], v[152:153], v[88:89]
    v_pk_add_f32 v[154:155], v[154:155], v[90:91]
    s_waitcnt lgkmcnt(0)
    v_pk_add_f32 v[156:157], v[156:157], v[92:93]
    v_pk_add_f32 v[158:159], v[158:159], v[94:95]
    v_max3_f32 v80, v144, v145, v146
    v_max3_f32 v81, v147, v148, v149
    v_max3_f32 v80, v80, v150, v151
    v_max3_f32 v81, v81, v152, v153
    v_max3_f32 v80, v80, v154, v155
    v_max3_f32 v81, v81, v156, v157
    v_max3_f32 v80, v80, v158, v159
    v_max_f32 v80, v80, v81
    v_mov_b32 v81, v80
    s_nop 1
    v_permlane32_swap_b32 v80, v81
    s_nop 1
    v_max_f32 v80, v80, v81
    v_mul_f32 v80, s62, v80
    v_pk_fma_f32 v[144:145], v[144:145], s[62:63], v[80:81] op_sel_hi:[1,0,0] neg_lo:[0,0,1] neg_hi:[0,0,1]
    v_pk_fma_f32 v[146:147], v[146:147], s[62:63], v[80:81] op_sel_hi:[1,0,0] neg_lo:[0,0,1] neg_hi:[0,0,1]
    v_pk_fma_f32 v[148:149], v[148:149], s[62:63], v[80:81] op_sel_hi:[1,0,0] neg_lo:[0,0,1] neg_hi:[0,0,1]
    v_pk_fma_f32 v[150:151], v[150:151], s[62:63], v[80:81] op_sel_hi:[1,0,0] neg_lo:[0,0,1] neg_hi:[0,0,1]
    v_pk_fma_f32 v[152:153], v[152:153], s[62:63], v[80:81] op_sel_hi:[1,0,0] neg_lo:[0,0,1] neg_hi:[0,0,1]
    v_pk_fma_f32 v[154:155], v[154:155], s[62:63], v[80:81] op_sel_hi:[1,0,0] neg_lo:[0,0,1] neg_hi:[0,0,1]
    v_pk_fma_f32 v[156:157], v[156:157], s[62:63], v[80:81] op_sel_hi:[1,0,0] neg_lo:[0,0,1] neg_hi:[0,0,1]
    v_pk_fma_f32 v[158:159], v[158:159], s[62:63], v[80:81] op_sel_hi:[1,0,0] neg_lo:[0,0,1] neg_hi:[0,0,1]
    v_exp_f32 v144, v144
    v_exp_f32 v145, v145
    v_exp_f32 v146, v146
    v_exp_f32 v147, v147
    v_exp_f32 v148, v148
    v_exp_f32 v149, v149
    v_exp_f32 v150, v150
    v_exp_f32 v151, v151
    v_exp_f32 v152, v152
    v_exp_f32 v153, v153
    v_exp_f32 v154, v154
    v_exp_f32 v155, v155
    v_exp_f32 v156, v156
    v_exp_f32 v157, v157
    v_exp_f32 v158, v158
    v_exp_f32 v159, v159
    s_nop 0
    v_pk_add_f32 v[82:83], v[144:145], v[152:153]
    v_pk_add_f32 v[84:85], v[146:147], v[154:155]
    v_pk_add_f32 v[86:87], v[148:149], v[156:157]
    v_pk_add_f32 v[88:89], v[150:151], v[158:159]
    v_pk_add_f32 v[82:83], v[82:83], v[86:87]
    v_pk_add_f32 v[84:85], v[84:85], v[88:89]
    v_pk_add_f32 v[82:83], v[82:83], v[84:85]
    v_add_f32 v80, v82, v83
    v_mov_b32 v81, v80
    s_nop 1
    v_permlane32_swap_b32 v80, v81
    s_nop 1
    v_add_f32 v80, v80, v81
    v_rcp_f32 v80, v80
    s_nop 0
    v_pk_mul_f32 v[144:145], v[144:145], v[80:81] op_sel_hi:[1,0]
    v_pk_mul_f32 v[146:147], v[146:147], v[80:81] op_sel_hi:[1,0]
    v_pk_mul_f32 v[148:149], v[148:149], v[80:81] op_sel_hi:[1,0]
    v_pk_mul_f32 v[150:151], v[150:151], v[80:81] op_sel_hi:[1,0]
    v_pk_mul_f32 v[152:153], v[152:153], v[80:81] op_sel_hi:[1,0]
    v_pk_mul_f32 v[154:155], v[154:155], v[80:81] op_sel_hi:[1,0]
    v_pk_mul_f32 v[156:157], v[156:157], v[80:81] op_sel_hi:[1,0]
    v_pk_mul_f32 v[158:159], v[158:159], v[80:81] op_sel_hi:[1,0]
    v_cvt_pk_bf16_f32 v84, v144, v145
    v_cvt_pk_bf16_f32 v85, v146, v147
    v_cvt_pk_bf16_f32 v86, v148, v149
    v_cvt_pk_bf16_f32 v87, v150, v151
    v_cvt_pk_bf16_f32 v88, v152, v153
    v_cvt_pk_bf16_f32 v89, v154, v155
    v_cvt_pk_bf16_f32 v90, v156, v157
    v_cvt_pk_bf16_f32 v91, v158, v159
    v_and_or_b32 v84, v84, s61, v6
    v_and_or_b32 v86, v86, s61, v7
    v_and_or_b32 v88, v88, s61, v6
    v_and_or_b32 v90, v90, s61, v7
    s_cmp_ge_u32 s49, 2
    s_cbranch_scc1 L_u0st
    buffer_store_dwordx4 v[84:87], v3, s[40:43], s69 offen sc1
    buffer_store_dwordx4 v[88:91], v3, s[40:43], s69 offen offset:1024 sc1
L_u0st:
    s_endpgm
L_n0_slow:
    s_mov_b32 s63, 0
L_n0_again:
    buffer_load_dwordx4 v[26:29], v10, s[24:27], 0 offen sc1
    s_waitcnt vmcnt(0)
    v_and_b32 v1, 0x100, v26
    v_cmp_eq_u32 vcc, 0, v1
    s_add_u32 s63, s63, 1
    s_cmp_ge_u32 s63, 65536
    s_cbranch_scc1 L_n0_ok
    s_cbranch_vccnz L_n0_again
    s_branch L_n0_ok
L_p00_slow:
    s_mov_b32 s63, 0
    s_add_u32 s55, s101, 0
    s_and_b32 s55, s55, 3
    s_lshl_b32 s55, s55, 15
    s_add_u32 s55, s55, s59
L_p00_again:
    buffer_load_dwordx4 v[16:19], v3, s[40:43], s55 offen offset:0 sc1
    buffer_load_dwordx4 v[20:23], v3, s[40:43], s55 offen offset:1024 sc1
    buffer_load_dwordx4 v[24:27], v3, s[40:43], s55 offen offset:2048 sc1
    buffer_load_dwordx4 v[28:31], v3, s[40:43], s55 offen offset:3072 sc1
    s_waitcnt vmcnt(0)
    v_xor_b32 v16, v6, v16
    v_xor_b32 v18, v7, v18
    v_xor_b32 v20, v6, v20
    v_xor_b32 v22, v7, v22
    v_xor_b32 v24, v6, v24
    v_xor_b32 v26, v7, v26
    v_xor_b32 v28, v6, v28
    v_xor_b32 v30, v7, v30
    v_or3_b32 v1, v16, v18, v20
    v_or3_b32 v2, v22, v24, v26
    v_or3_b32 v1, v1, v28, v30
    v_or_b32 v1, v1, v2
    v_and_b32 v1, 0xc000c000, v1
    v_cmp_ne_u32 vcc, 0, v1
    s_add_u32 s63, s63, 1
    s_cmp_ge_u32 s63, 65536
    s_cbranch_scc1 L_p00_ok
    s_cbranch_vccnz L_p00_again
    s_branch L_p00_ok
L_p01_slow:
    s_mov_b32 s63, 0
    s_add_u32 s55, s101, 1
    s_and_b32 s55, s55, 3
    s_lshl_b32 s55, s55, 15
    s_add_u32 s55, s55, s59
L_p01_again:
    buffer_load_dwordx4 v[16:19], v3, s[40:43], s55 offen offset:0 sc1
    buffer_load_dwordx4 v[20:23], v3, s[40:43], s55 offen offset:1024 sc1
    buffer_load_dwordx4 v[24:27], v3, s[40:43], s55 offen offset:2048 sc1
    buffer_load_dwordx4 v[28:31], v3, s[40:43], s55 offen offset:3072 sc1
    s_waitcnt vmcnt(0)
    v_xor_b32 v16, v6, v16
    v_xor_b32 v18, v7, v18
    v_xor_b32 v20, v6, v20
    v_xor_b32 v22, v7, v22
    v_xor_b32 v24, v6, v24
    v_xor_b32 v26, v7, v26
    v_xor_b32 v28, v6, v28
    v_xor_b32 v30, v7, v30
    v_or3_b32 v1, v16, v18, v20
    v_or3_b32 v2, v22, v24, v26
    v_or3_b32 v1, v1, v28, v30
    v_or_b32 v1, v1, v2
    v_and_b32 v1, 0xc000c000, v1
    v_cmp_ne_u32 vcc, 0, v1
    s_add_u32 s63, s63, 1
    s_cmp_ge_u32 s63, 65536
    s_cbranch_scc1 L_p01_ok
    s_cbranch_vccnz L_p01_again
    s_branch L_p01_ok
L_p02_slow:
    s_mov_b32 s63, 0
    s_add_u32 s55, s101, 2
    s_and_b32 s55, s55, 3
    s_lshl_b32 s55, s55, 15
    s_add_u32 s55, s55, s59
L_p02_again:
    buffer_load_dwordx4 v[16:19], v3, s[40:43], s55 offen offset:0 sc1
    buffer_load_dwordx4 v[20:23], v3, s[40:43], s55 offen offset:1024 sc1
    buffer_load_dwordx4 v[24:27], v3, s[40:43], s55 offen offset:2048 sc1
    buffer_load_dwordx4 v[28:31], v3, s[40:43], s55 offen offset:3072 sc1
    s_waitcnt vmcnt(0)
    v_xor_b32 v16, v6, v16
    v_xor_b32 v18, v7, v18
    v_xor_b32 v20, v6, v20
    v_xor_b32 v22, v7, v22
    v_xor_b32 v24, v6, v24
    v_xor_b32 v26, v7, v26
    v_xor_b32 v28, v6, v28
    v_xor_b32 v30, v7, v30
    v_or3_b32 v1, v16, v18, v20
    v_or3_b32 v2, v22, v24, v26
    v_or3_b32 v1, v1, v28, v30
    v_or_b32 v1, v1, v2
    v_and_b32 v1, 0xc000c000, v1
    v_cmp_ne_u32 vcc, 0, v1
    s_add_u32 s63, s63, 1
    s_cmp_ge_u32 s63, 65536
    s_cbranch_scc1 L_p02_ok
    s_cbranch_vccnz L_p02_again
    s_branch L_p02_ok
L_p03_slow:
    s_mov_b32 s63, 0
    s_add_u32 s55, s101, 3
    s_and_b32 s55, s55, 3
    s_lshl_b32 s55, s55, 15
    s_add_u32 s55, s55, s59
L_p03_again:
    buffer_load_dwordx4 v[16:19], v3, s[40:43], s55 offen offset:0 sc1
    buffer_load_dwordx4 v[20:23], v3, s[40:43], s55 offen offset:1024 sc1
    buffer_load_dwordx4 v[24:27], v3, s[40:43], s55 offen offset:2048 sc1
    buffer_load_dwordx4 v[28:31], v3, s[40:43], s55 offen offset:3072 sc1
    s_waitcnt vmcnt(0)
    v_xor_b32 v16, v6, v16
    v_xor_b32 v18, v7, v18
    v_xor_b32 v20, v6, v20
    v_xor_b32 v22, v7, v22
    v_xor_b32 v24, v6, v24
    v_xor_b32 v26, v7, v26
    v_xor_b32 v28, v6, v28
    v_xor_b32 v30, v7, v30
    v_or3_b32 v1, v16, v18, v20
    v_or3_b32 v2, v22, v24, v26
    v_or3_b32 v1, v1, v28, v30
    v_or_b32 v1, v1, v2
    v_and_b32 v1, 0xc000c000, v1
    v_cmp_ne_u32 vcc, 0, v1
    s_add_u32 s63, s63, 1
    s_cmp_ge_u32 s63, 65536
    s_cbranch_scc1 L_p03_ok
    s_cbranch_vccnz L_p03_again
    s_branch L_p03_ok
L_g0_slow:
    s_mov_b32 s63, 0
L_g0_again:
    buffer_load_dwordx4 v[32:35], v3, s[40:43], s15 offen offset:0 sc1
    buffer_load_dwordx4 v[36:39], v3, s[40:43], s15 offen offset:1024 sc1
    buffer_load_dwordx4 v[40:43], v3, s[40:43], s16 offen offset:0 sc1
    buffer_load_dwordx4 v[44:47], v3, s[40:43], s16 offen offset:1024 sc1
    buffer_load_dwordx4 v[56:59], v3, s[40:43], s17 offen offset:0 sc1
    buffer_load_dwordx4 v[60:63], v3, s[40:43], s17 offen offset:1024 sc1
    s_waitcnt vmcnt(0)
    v_xor_b32 v32, v0, v32
    v_xor_b32 v36, v0, v36
    v_xor_b32 v40, v0, v40
    v_xor_b32 v44, v0, v44
    v_xor_b32 v56, v0, v56
    v_xor_b32 v60, v0, v60
    v_or3_b32 v1, v32, v36, v40
    v_or3_b32 v2, v44, v56, v60
    v_or_b32 v1, v1, v2
    v_and_b32 v1, 0xff, v1
    v_cmp_ne_u32 vcc, 0, v1
    s_add_u32 s63, s63, 1
    s_cmp_ge_u32 s63, 65536
    s_cbranch_scc1 L_g0_ok
    s_cbranch_vccnz L_g0_again
    s_branch L_g0_ok
L_cls1:
L_comp1:
    s_barrier
    s_barrier
    ds_read_b128 v[128:131], v16 offset:0
    ds_read_b128 v[132:135], v16 offset:2048
    ds_read_b64_tr_b16 v[96:97], v18 offset:0
    ds_read_b64_tr_b16 v[98:99], v18 offset:512
    ds_read_b64_tr_b16 v[100:101], v19 offset:0
    ds_read_b64_tr_b16 v[102:103], v19 offset:512
    ds_read_b64_tr_b16 v[104:105], v20 offset:0
    ds_read_b64_tr_b16 v[106:107], v20 offset:512
    ds_read_b64_tr_b16 v[108:109], v21 offset:0
    ds_read_b64_tr_b16 v[110:111], v21 offset:512
    ds_read_b64_tr_b16 v[112:113], v18 offset:24576
    ds_read_b64_tr_b16 v[114:115], v18 offset:25088
    ds_read_b64_tr_b16 v[116:117], v19 offset:24576
    ds_read_b64_tr_b16 v[118:119], v19 offset:25088
    ds_read_b64_tr_b16 v[120:121], v20 offset:24576
    ds_read_b64_tr_b16 v[122:123], v20 offset:25088
    ds_read_b64_tr_b16 v[124:125], v21 offset:24576
    ds_read_b64_tr_b16 v[126:127], v21 offset:25088
    s_barrier
    s_waitcnt lgkmcnt(12)
    v_mfma_f32_16x16x32_bf16 v[32:35], v[96:99], v[128:131], 0
    ds_read_b128 v[136:139], v17 offset:0
    v_mfma_f32_16x16x32_bf16 v[36:39], v[96:99], v[132:135], 0
    v_mfma_f32_16x16x32_bf16 v[40:43], v[100:103], v[128:131], 0
    ds_read_b128 v[140:143], v17 offset:2048
    ds_read_b64_tr_b16 v[96:97], v18 offset:4096
    v_mfma_f32_16x16x32_bf16 v[44:47], v[100:103], v[132:135], 0
    ds_read_b64_tr_b16 v[98:99], v18 offset:4608
    s_waitcnt lgkmcnt(12)
    v_mfma_f32_16x16x32_bf16 v[48:51], v[104:107], v[128:131], 0
    ds_read_b64_tr_b16 v[100:101], v19 offset:4096
    v_mfma_f32_16x16x32_bf16 v[52:55], v[104:107], v[132:135], 0
    ds_read_b64_tr_b16 v[102:103], v19 offset:4608
    v_mfma_f32_16x16x32_bf16 v[56:59], v[108:111], v[128:131], 0
    ds_read_b64_tr_b16 v[104:105], v20 offset:4096
    v_mfma_f32_16x16x32_bf16 v[60:63], v[108:111], v[132:135], 0
    ds_read_b64_tr_b16 v[106:107], v20 offset:4608
    s_waitcnt lgkmcnt(12)
    v_mfma_f32_16x16x32_bf16 v[64:67], v[112:115], v[128:131], 0
    ds_read_b64_tr_b16 v[108:109], v21 offset:4096
    v_mfma_f32_16x16x32_bf16 v[68:71], v[112:115], v[132:135], 0
    ds_read_b64_tr_b16 v[110:111], v21 offset:4608
    v_mfma_f32_16x16x32_bf16 v[72:75], v[116:119], v[128:131], 0
    ds_read_b64_tr_b16 v[112:113], v18 offset:28672
    v_mfma_f32_16x16x32_bf16 v[76:79], v[116:119], v[132:135], 0
    ds_read_b64_tr_b16 v[114:115], v18 offset:29184
    s_waitcnt lgkmcnt(12)
    v_mfma_f32_16x16x32_bf16 v[80:83], v[120:123], v[128:131], 0
    ds_read_b64_tr_b16 v[116:117], v19 offset:28672
    v_mfma_f32_16x16x32_bf16 v[84:87], v[120:123], v[132:135], 0
    ds_read_b64_tr_b16 v[118:119], v19 offset:29184
    v_mfma_f32_16x16x32_bf16 v[88:91], v[124:127], v[128:131], 0
    ds_read_b64_tr_b16 v[120:121], v20 offset:28672
    v_mfma_f32_16x16x32_bf16 v[92:95], v[124:127], v[132:135], 0
    ds_read_b64_tr_b16 v[122:123], v20 offset:29184
    s_barrier
    s_waitcnt lgkmcnt(10)
    v_mfma_f32_16x16x32_bf16 v[32:35], v[96:99], v[136:139], v[32:35]
    ds_read_b64_tr_b16 v[124:125], v21 offset:28672
    v_mfma_f32_16x16x32_bf16 v[36:39], v[96:99], v[140:143], v[36:39]
    ds_read_b64_tr_b16 v[126:127], v21 offset:29184
    v_mfma_f32_16x16x32_bf16 v[40:43], v[100:103], v[136:139], v[40:43]
    v_mfma_f32_16x16x32_bf16 v[44:47], v[100:103], v[140:143], v[44:47]
    s_waitcnt lgkmcnt(8)
    v_mfma_f32_16x16x32_bf16 v[48:51], v[104:107], v[136:139], v[48:51]
    v_mfma_f32_16x16x32_bf16 v[52:55], v[104:107], v[140:143], v[52:55]
    v_mfma_f32_16x16x32_bf16 v[56:59], v[108:111], v[136:139], v[56:59]
    v_mfma_f32_16x16x32_bf16 v[60:63], v[108:111], v[140:143], v[60:63]
    s_waitcnt lgkmcnt(4)
    v_mfma_f32_16x16x32_bf16 v[64:67], v[112:115], v[136:139], v[64:67]
    v_mfma_f32_16x16x32_bf16 v[68:71], v[112:115], v[140:143], v[68:71]
    v_mfma_f32_16x16x32_bf16 v[72:75], v[116:119], v[136:139], v[72:75]
    v_mfma_f32_16x16x32_bf16 v[76:79], v[116:119], v[140:143], v[76:79]
    s_waitcnt lgkmcnt(0)
    v_mfma_f32_16x16x32_bf16 v[80:83], v[120:123], v[136:139], v[80:83]
    v_mfma_f32_16x16x32_bf16 v[84:87], v[120:123], v[140:143], v[84:87]
    v_mfma_f32_16x16x32_bf16 v[88:91], v[124:127], v[136:139], v[88:91]
    v_mfma_f32_16x16x32_bf16 v[92:95], v[124:127], v[140:143], v[92:95]
    s_barrier
    ds_read_b128 v[128:131], v16 offset:8192
    ds_read_b128 v[132:135], v16 offset:10240
    ds_read_b64_tr_b16 v[96:97], v18 offset:8192
    ds_read_b64_tr_b16 v[98:99], v18 offset:8704
    ds_read_b64_tr_b16 v[100:101], v19 offset:8192
    ds_read_b64_tr_b16 v[102:103], v19 offset:8704
    ds_read_b64_tr_b16 v[104:105], v20 offset:8192
    ds_read_b64_tr_b16 v[106:107], v20 offset:8704
    ds_read_b64_tr_b16 v[108:109], v21 offset:8192
    ds_read_b64_tr_b16 v[110:111], v21 offset:8704
    ds_read_b64_tr_b16 v[112:113], v18 offset:32768
    ds_read_b64_tr_b16 v[114:115], v18 offset:33280
    ds_read_b64_tr_b16 v[116:117], v19 offset:32768
    ds_read_b64_tr_b16 v[118:119], v19 offset:33280
    ds_read_b64_tr_b16 v[120:121], v20 offset:32768
    ds_read_b64_tr_b16 v[122:123], v20 offset:33280
    ds_read_b64_tr_b16 v[124:125], v21 offset:32768
    ds_read_b64_tr_b16 v[126:127], v21 offset:33280
    s_barrier
    s_waitcnt lgkmcnt(12)
    v_mfma_f32_16x16x32_bf16 v[32:35], v[96:99], v[128:131], v[32:35]
    ds_read_b128 v[136:139], v17 offset:8192
    v_mfma_f32_16x16x32_bf16 v[36:39], v[96:99], v[132:135], v[36:39]
    v_mfma_f32_16x16x32_bf16 v[40:43], v[100:103], v[128:131], v[40:43]
    ds_read_b128 v[140:143], v17 offset:10240
    ds_read_b64_tr_b16 v[96:97], v18 offset:12288
    v_mfma_f32_16x16x32_bf16 v[44:47], v[100:103], v[132:135], v[44:47]
    ds_read_b64_tr_b16 v[98:99], v18 offset:12800
    s_waitcnt lgkmcnt(12)
    v_mfma_f32_16x16x32_bf16 v[48:51], v[104:107], v[128:131], v[48:51]
    ds_read_b64_tr_b16 v[100:101], v19 offset:12288
    v_mfma_f32_16x16x32_bf16 v[52:55], v[104:107], v[132:135], v[52:55]
    ds_read_b64_tr_b16 v[102:103], v19 offset:12800
    v_mfma_f32_16x16x32_bf16 v[56:59], v[108:111], v[128:131], v[56:59]
    ds_read_b64_tr_b16 v[104:105], v20 offset:12288
    v_mfma_f32_16x16x32_bf16 v[60:63], v[108:111], v[132:135], v[60:63]
    ds_read_b64_tr_b16 v[106:107], v20 offset:12800
    s_waitcnt lgkmcnt(12)
    v_mfma_f32_16x16x32_bf16 v[64:67], v[112:115], v[128:131], v[64:67]
    ds_read_b64_tr_b16 v[108:109], v21 offset:12288
    v_mfma_f32_16x16x32_bf16 v[68:71], v[112:115], v[132:135], v[68:71]
    ds_read_b64_tr_b16 v[110:111], v21 offset:12800
    v_mfma_f32_16x16x32_bf16 v[72:75], v[116:119], v[128:131], v[72:75]
    ds_read_b64_tr_b16 v[112:113], v18 offset:36864
    v_mfma_f32_16x16x32_bf16 v[76:79], v[116:119], v[132:135], v[76:79]
    ds_read_b64_tr_b16 v[114:115], v18 offset:37376
    s_waitcnt lgkmcnt(12)
    v_mfma_f32_16x16x32_bf16 v[80:83], v[120:123], v[128:131], v[80:83]
    ds_read_b64_tr_b16 v[116:117], v19 offset:36864
    v_mfma_f32_16x16x32_bf16 v[84:87], v[120:123], v[132:135], v[84:87]
    ds_read_b64_tr_b16 v[118:119], v19 offset:37376
    v_mfma_f32_16x16x32_bf16 v[88:91], v[124:127], v[128:131], v[88:91]
    ds_read_b64_tr_b16 v[120:121], v20 offset:36864
    v_mfma_f32_16x16x32_bf16 v[92:95], v[124:127], v[132:135], v[92:95]
    ds_read_b64_tr_b16 v[122:123], v20 offset:37376
    s_barrier
    s_waitcnt lgkmcnt(10)
    v_mfma_f32_16x16x32_bf16 v[32:35], v[96:99], v[136:139], v[32:35]
    ds_read_b64_tr_b16 v[124:125], v21 offset:36864
    ds_read_b64_tr_b16 v[126:127], v21 offset:37376
    v_mfma_f32_16x16x32_bf16 v[36:39], v[96:99], v[140:143], v[36:39]
    ds_read_b128 v[128:131], v16 offset:16384
    v_mfma_f32_16x16x32_bf16 v[40:43], v[100:103], v[136:139], v[40:43]
    ds_read_b128 v[132:135], v16 offset:18432
    ds_read_b64_tr_b16 v[96:97], v18 offset:16384
    v_mfma_f32_16x16x32_bf16 v[44:47], v[100:103], v[140:143], v[44:47]
    ds_read_b64_tr_b16 v[98:99], v18 offset:16896
    s_waitcnt lgkmcnt(12)
    v_mfma_f32_16x16x32_bf16 v[48:51], v[104:107], v[136:139], v[48:51]
    ds_read_b64_tr_b16 v[100:101], v19 offset:16384
    v_mfma_f32_16x16x32_bf16 v[52:55], v[104:107], v[140:143], v[52:55]
    ds_read_b64_tr_b16 v[102:103], v19 offset:16896
    v_mfma_f32_16x16x32_bf16 v[56:59], v[108:111], v[136:139], v[56:59]
    ds_read_b64_tr_b16 v[104:105], v20 offset:16384
    v_mfma_f32_16x16x32_bf16 v[60:63], v[108:111], v[140:143], v[60:63]
    ds_read_b64_tr_b16 v[106:107], v20 offset:16896
    s_waitcnt lgkmcnt(12)
    v_mfma_f32_16x16x32_bf16 v[64:67], v[112:115], v[136:139], v[64:67]
    ds_read_b64_tr_b16 v[108:109], v21 offset:16384
    v_mfma_f32_16x16x32_bf16 v[68:71], v[112:115], v[140:143], v[68:71]
    ds_read_b64_tr_b16 v[110:111], v21 offset:16896
    v_mfma_f32_16x16x32_bf16 v[72:75], v[116:119], v[136:139], v[72:75]
    ds_read_b64_tr_b16 v[112:113], v18 offset:40960
    v_mfma_f32_16x16x32_bf16 v[76:79], v[116:119], v[140:143], v[76:79]
    ds_read_b64_tr_b16 v[114:115], v18 offset:41472
    s_waitcnt lgkmcnt(12)
    v_mfma_f32_16x16x32_bf16 v[80:83], v[120:123], v[136:139], v[80:83]
    ds_read_b64_tr_b16 v[116:117], v19 offset:40960
    v_mfma_f32_16x16x32_bf16 v[84:87], v[120:123], v[140:143], v[84:87]
    ds_read_b64_tr_b16 v[118:119], v19 offset:41472
    v_mfma_f32_16x16x32_bf16 v[88:91], v[124:127], v[136:139], v[88:91]
    ds_read_b64_tr_b16 v[120:121], v20 offset:40960
    v_mfma_f32_16x16x32_bf16 v[92:95], v[124:127], v[140:143], v[92:95]
    ds_read_b64_tr_b16 v[122:123], v20 offset:41472
    s_barrier
    s_waitcnt lgkmcnt(10)
    v_mfma_f32_16x16x32_bf16 v[32:35], v[96:99], v[128:131], v[32:35]
    ds_read_b64_tr_b16 v[124:125], v21 offset:40960
    ds_read_b64_tr_b16 v[126:127], v21 offset:41472
    v_mfma_f32_16x16x32_bf16 v[36:39], v[96:99], v[132:135], v[36:39]
    ds_read_b128 v[136:139], v17 offset:16384
    v_mfma_f32_16x16x32_bf16 v[40:43], v[100:103], v[128:131], v[40:43]
    ds_read_b128 v[140:143], v17 offset:18432
    ds_read_b64_tr_b16 v[96:97], v18 offset:20480
    v_mfma_f32_16x16x32_bf16 v[44:47], v[100:103], v[132:135], v[44:47]
    ds_read_b64_tr_b16 v[98:99], v18 offset:20992
    s_waitcnt lgkmcnt(12)
    v_mfma_f32_16x16x32_bf16 v[48:51], v[104:107], v[128:131], v[48:51]
    ds_read_b64_tr_b16 v[100:101], v19 offset:20480
    v_mfma_f32_16x16x32_bf16 v[52:55], v[104:107], v[132:135], v[52:55]
    ds_read_b64_tr_b16 v[102:103], v19 offset:20992
    v_mfma_f32_16x16x32_bf16 v[56:59], v[108:111], v[128:131], v[56:59]
    ds_read_b64_tr_b16 v[104:105], v20 offset:20480
    v_mfma_f32_16x16x32_bf16 v[60:63], v[108:111], v[132:135], v[60:63]
    ds_read_b64_tr_b16 v[106:107], v20 offset:20992
    s_waitcnt lgkmcnt(12)
    v_mfma_f32_16x16x32_bf16 v[64:67], v[112:115], v[128:131], v[64:67]
    ds_read_b64_tr_b16 v[108:109], v21 offset:20480
    v_mfma_f32_16x16x32_bf16 v[68:71], v[112:115], v[132:135], v[68:71]
    ds_read_b64_tr_b16 v[110:111], v21 offset:20992
    v_mfma_f32_16x16x32_bf16 v[72:75], v[116:119], v[128:131], v[72:75]
    ds_read_b64_tr_b16 v[112:113], v18 offset:45056
    v_mfma_f32_16x16x32_bf16 v[76:79], v[116:119], v[132:135], v[76:79]
    ds_read_b64_tr_b16 v[114:115], v18 offset:45568
    s_waitcnt lgkmcnt(12)
    v_mfma_f32_16x16x32_bf16 v[80:83], v[120:123], v[128:131], v[80:83]
    ds_read_b64_tr_b16 v[116:117], v19 offset:45056
    v_mfma_f32_16x16x32_bf16 v[84:87], v[120:123], v[132:135], v[84:87]
    ds_read_b64_tr_b16 v[118:119], v19 offset:45568
    v_mfma_f32_16x16x32_bf16 v[88:91], v[124:127], v[128:131], v[88:91]
    ds_read_b64_tr_b16 v[120:121], v20 offset:45056
    v_mfma_f32_16x16x32_bf16 v[92:95], v[124:127], v[132:135], v[92:95]
    ds_read_b64_tr_b16 v[122:123], v20 offset:45568
    s_barrier
    s_waitcnt lgkmcnt(10)
    v_mfma_f32_16x16x32_bf16 v[32:35], v[96:99], v[136:139], v[32:35]
    ds_read_b64_tr_b16 v[124:125], v21 offset:45056
    v_mfma_f32_16x16x32_bf16 v[36:39], v[96:99], v[140:143], v[36:39]
    ds_read_b64_tr_b16 v[126:127], v21 offset:45568
    v_mfma_f32_16x16x32_bf16 v[40:43], v[100:103], v[136:139], v[40:43]
    v_mfma_f32_16x16x32_bf16 v[44:47], v[100:103], v[140:143], v[44:47]
    s_waitcnt lgkmcnt(8)
    v_mfma_f32_16x16x32_bf16 v[48:51], v[104:107], v[136:139], v[48:51]
    v_mfma_f32_16x16x32_bf16 v[52:55], v[104:107], v[140:143], v[52:55]
    v_mfma_f32_16x16x32_bf16 v[56:59], v[108:111], v[136:139], v[56:59]
    v_mfma_f32_16x16x32_bf16 v[60:63], v[108:111], v[140:143], v[60:63]
    s_waitcnt lgkmcnt(4)
    v_mfma_f32_16x16x32_bf16 v[64:67], v[112:115], v[136:139], v[64:67]
    v_mfma_f32_16x16x32_bf16 v[68:71], v[112:115], v[140:143], v[68:71]
    v_mfma_f32_16x16x32_bf16 v[72:75], v[116:119], v[136:139], v[72:75]
    v_mfma_f32_16x16x32_bf16 v[76:79], v[116:119], v[140:143], v[76:79]
    s_waitcnt lgkmcnt(0)
    v_mfma_f32_16x16x32_bf16 v[80:83], v[120:123], v[136:139], v[80:83]
    v_mfma_f32_16x16x32_bf16 v[84:87], v[120:123], v[140:143], v[84:87]
    v_mfma_f32_16x16x32_bf16 v[88:91], v[124:127], v[136:139], v[88:91]
    v_mfma_f32_16x16x32_bf16 v[92:95], v[124:127], v[140:143], v[92:95]
    s_barrier
    ds_read_b128 v[160:163], v22 offset:0
    ds_read_b128 v[164:167], v23 offset:0
    ds_read_b128 v[168:171], v24 offset:0
    ds_read_b128 v[172:175], v25 offset:0
    s_barrier
    ds_read_b128 v[176:179], v22 offset:4096
    ds_read_b128 v[180:183], v23 offset:4096
    ds_read_b128 v[184:187], v24 offset:4096
    ds_read_b128 v[188:191], v25 offset:4096
    s_waitcnt lgkmcnt(4)
    s_barrier
    ds_read_b128 v[128:131], v16 offset:24576
    ds_read_b128 v[132:135], v16 offset:26624
    ds_read_b64_tr_b16 v[96:97], v18 offset:8192
    ds_read_b64_tr_b16 v[98:99], v18 offset:8704
    ds_read_b64_tr_b16 v[100:101], v19 offset:8192
    ds_read_b64_tr_b16 v[102:103], v19 offset:8704
    ds_read_b64_tr_b16 v[104:105], v20 offset:8192
    ds_read_b64_tr_b16 v[106:107], v20 offset:8704
    ds_read_b64_tr_b16 v[108:109], v21 offset:8192
    ds_read_b64_tr_b16 v[110:111], v21 offset:8704
    ds_read_b64_tr_b16 v[112:113], v18 offset:32768
    ds_read_b64_tr_b16 v[114:115], v18 offset:33280
    ds_read_b64_tr_b16 v[116:117], v19 offset:32768
    ds_read_b64_tr_b16 v[118:119], v19 offset:33280
    ds_read_b64_tr_b16 v[120:121], v20 offset:32768
    ds_read_b64_tr_b16 v[122:123], v20 offset:33280
    ds_read_b64_tr_b16 v[124:125], v21 offset:32768
    ds_read_b64_tr_b16 v[126:127], v21 offset:33280
    s_waitcnt lgkmcnt(15)
    s_branch L_cjoin
L_end:
    s_endpgm
.section .rodata,"a"
.p2align 6
.amdhsa_kernel standalone__mha_block_cached__near_ridge_kernel
  .amdhsa_next_free_vgpr 256
  .amdhsa_next_free_sgpr 102
  .amdhsa_accum_offset 256
  .amdhsa_group_segment_fixed_size 0
  .amdhsa_kernarg_size 64
  .amdhsa_user_sgpr_count 2
  .amdhsa_user_sgpr_kernarg_segment_ptr 1
  .amdhsa_system_sgpr_workgroup_id_x 1
.end_amdhsa_kernel
```
